```python
import torch

def _softmax(x, axis=-1):
    return torch.softmax(x, dim=axis)
def _gelu(x):
    return torch.nn.functional.gelu(x, approximate="tanh")
def _silu(x):
    return torch.nn.functional.silu(x)
def _sigmoid(x):
    return torch.sigmoid(x)
def _layernorm(x, axis=-1, eps=1e-5):
    m = x.mean(dim=axis, keepdim=True)
    v = x.var(dim=axis, keepdim=True, unbiased=False)
    return (x - m) / torch.sqrt(v + eps)
def _scatter_add(tgt, idx, src, axis=0):
    return tgt.clone().index_add_(axis, idx, src)
def _segment_sum(src, seg, n):
    out = torch.zeros((n,) + src.shape[1:], dtype=src.dtype)
    return out.index_add_(0, seg, src)
def _pad(x, pw):
    flat = tuple(v for pair in reversed(pw) for v in pair)
    return torch.nn.functional.pad(x, flat)

kernel_name = 'recurrent_scan__ssm_conv_s5__glu_gated_reglu__prompt'

def setup_inputs():

    _w = (lambda a: (lambda t: t.to(torch.bfloat16) if t.is_floating_point() else t)(torch.as_tensor(a)))
    def _A_setup():
        B, S, D = 1, 2048, 512
        P = D
        Lambda_re = -0.5 * (lambda _x: torch.exp(torch.as_tensor(_x)))((lambda *s: torch.randn(*s, dtype=torch.bfloat16) * 0.8)(P))
        Lambda_im = (lambda *s: torch.randn(*s, dtype=torch.bfloat16) * 0.8)(P) * 1.0
        B_re = (lambda *s: torch.randn(*s, dtype=torch.bfloat16) * 0.8)(P, D) * (D ** -0.5)
        B_im = (lambda *s: torch.randn(*s, dtype=torch.bfloat16) * 0.8)(P, D) * (D ** -0.5)
        C_re = (lambda *s: torch.randn(*s, dtype=torch.bfloat16) * 0.8)(D, P) * (P ** -0.5)
        C_im = (lambda *s: torch.randn(*s, dtype=torch.bfloat16) * 0.8)(D, P) * (P ** -0.5)
        log_dt = (lambda *s: torch.randn(*s, dtype=torch.bfloat16) * 0.8)(P) * 0.3 - 2.0
        Dskip = (lambda *s: torch.randn(*s, dtype=torch.bfloat16) * 0.8)(D)
        return {
            "x": _w((lambda *s: torch.randn(*s, dtype=torch.bfloat16) * 0.05)(B, S, D)),
            "Lambda_re": _w(Lambda_re),
            "Lambda_im": _w(Lambda_im),
            "B_re": _w(B_re),
            "B_im": _w(B_im),
            "C_re": _w(C_re),
            "C_im": _w(C_im),
            "log_dt": _w(log_dt),
            "Dskip": _w(Dskip),
        }
    _A_in = _A_setup()

    def _B_setup():
        B, S, D, F = 1, 2048, 512, 1376
        return {
            "x": _w((lambda *s: torch.randn(*s, dtype=torch.bfloat16) * 0.05)(B, S, D)),
            "W_gate": _w((lambda *s: torch.randn(*s, dtype=torch.bfloat16) * 0.2)(D, F) * (2.0 / D) ** 0.5),
            "W_up": _w((lambda *s: torch.randn(*s, dtype=torch.bfloat16) * 0.2)(D, F) * (2.0 / D) ** 0.5),
            "W_down": _w((lambda *s: torch.randn(*s, dtype=torch.bfloat16) * 0.2)(F, D) * (1.0 / F) ** 0.5),
        }
    _B_in = _B_setup()

    return {
        "A_x": _A_in["x"],
        "A_Lambda_re": _A_in["Lambda_re"],
        "A_Lambda_im": _A_in["Lambda_im"],
        "A_B_re": _A_in["B_re"],
        "A_B_im": _A_in["B_im"],
        "A_C_re": _A_in["C_re"],
        "A_C_im": _A_in["C_im"],
        "A_log_dt": _A_in["log_dt"],
        "A_Dskip": _A_in["Dskip"],
        "B_x": _B_in["x"],
        "B_W_gate": _B_in["W_gate"],
        "B_W_up": _B_in["W_up"],
        "B_W_down": _B_in["W_down"],
    }

def reference(A_x, A_Lambda_re, A_Lambda_im, A_B_re, A_B_im, A_C_re, A_C_im, A_log_dt, A_Dskip, B_x, B_W_gate, B_W_up, B_W_down):
    def _A_ref(x, Lambda_re, Lambda_im, B_re, B_im, C_re, C_im, log_dt, Dskip):
        Bsz, L, H = x.shape
        Lam = Lambda_re + 1j * Lambda_im
        Bmat = B_re + 1j * B_im
        Cmat = C_re + 1j * C_im
        dt = torch.exp(log_dt)
        Lam_bar = torch.exp(dt * Lam)
        B_bar = ((Lam_bar - 1.0) / Lam)[:, None] * Bmat
        Bu = torch.einsum("bld,pd->blp", x + 0j, B_bar)
        h = torch.zeros_like(Bu[:, 0, :])
        hs = []
        for t in range(L):
            h = Lam_bar[None, :] * h + Bu[:, t, :]
            hs.append(h)
        hseq = torch.stack(hs, 1)
        y = 2.0 * torch.einsum("blp,dp->bld", hseq, Cmat).real + x * Dskip[None, None, :]
        return y

    def _B_ref(x, W_gate, W_up, W_down):
        gate = torch.einsum("bsd,df->bsf", x, W_gate)
        up = torch.einsum("bsd,df->bsf", x, W_up)
        gate = gate * (lambda x, dt: x.to(dt))(gate > 0, gate.dtype)
        h = gate * up
        return torch.einsum("bsf,fd->bsd", h, W_down)

    x = A_x
    xn = _layernorm(x, axis=-1)
    s = _A_ref(xn, A_Lambda_re, A_Lambda_im, A_B_re, A_B_im, A_C_re, A_C_im, A_log_dt, A_Dskip)
    g = _silu(_B_ref(xn, B_W_gate, B_W_up, B_W_down))
    return x + s * g
```

```asm
; @launch grid=(256,1,1) block=(512,1,1) lds=162368
.amdgcn_target "amdgcn-amd-amdhsa--gfx950"
.text
.globl recurrent_scan__ssm_conv_s5__glu_gated_reglu__prompt_kernel
.p2align 8
.type recurrent_scan__ssm_conv_s5__glu_gated_reglu__prompt_kernel,@function
recurrent_scan__ssm_conv_s5__glu_gated_reglu__prompt_kernel:
    s_cmp_ge_u32 s2, 256
    s_cbranch_scc1 F_END
    s_load_dwordx8 s[64:71], s[0:1], 0
    s_load_dwordx2 s[72:73], s[0:1], 32
    s_load_dwordx4 s[76:79], s[0:1], 80
    s_load_dwordx2 s[82:83], s[0:1], 120
    s_load_dwordx2 s[74:75], s[0:1], 56
    s_load_dwordx4 s[4:7], s[0:1], 40
    s_load_dwordx4 s[24:27], s[0:1], 96
    s_load_dwordx2 s[96:97], s[0:1], 64
    v_lshrrev_b32 v27, 6, v0
    v_and_b32 v26, 63, v0
    v_readfirstlane_b32 s40, v27
    s_and_b32 s52, s2, 7
    s_lshr_b32 s53, s2, 3
    s_and_b32 s41, s40, 3
    s_lshr_b32 s42, s52, 2
    s_lshl_b32 s42, s42, 3
    s_and_b32 s54, s53, 7
    s_add_u32 s42, s42, s54
    s_and_b32 s43, s52, 3
    s_lshl_b32 s43, s43, 2
    s_lshr_b32 s54, s53, 3
    s_add_u32 s43, s43, s54
    s_lshl_b32 s44, s43, 1
    s_add_u32 s44, s44, s42
    s_and_b32 s44, s44, 7
    s_and_b32 s101, s44, 7
    s_mul_i32 s54, s43, 3
    s_lshl_b32 s55, s43, 1
    s_add_u32 s55, s55, 11
    s_cmp_lt_u32 s43, 11
    s_cselect_b32 s45, s54, s55
    s_cselect_b32 s51, 0, 1073741824
    s_mov_b32 s59, 0xffff0000
    v_lshrrev_b32 v27, 3, v26
    v_and_b32 v28, 7, v26
    v_lshrrev_b32 v30, 1, v27
    v_xor_b32 v30, v30, v28
    v_lshlrev_b32 v30, 4, v30
    v_lshl_add_u32 v13, v27, 10, v30
    v_xor_b32 v14, 64, v13
    v_lshrrev_b32 v31, 2, v27
    v_lshlrev_b32 v31, 4, v31
    v_and_or_b32 v31, v27, 3, v31
    v_lshl_add_u32 v11, v31, 10, v30
    v_xor_b32 v12, 64, v11
    v_add_u32 v30, 0, v26
    v_mul_u32_u24 v31, 0x556, v30
    v_lshrrev_b32 v31, 14, v31
    v_mul_u32_u24 v29, 12, v31
    v_sub_u32 v30, v30, v29
    v_mul_u32_u24 v31, 0xac0, v31
    v_lshl_add_u32 v15, v30, 4, v31
    v_cmp_lt_u32 vcc, 7, v30
    v_mov_b32 v29, s51
    s_nop 0
    v_cndmask_b32 v29, 0, v29, vcc
    v_add_u32 v15, v15, v29
    v_add_u32 v30, 64, v26
    v_mul_u32_u24 v31, 0x556, v30
    v_lshrrev_b32 v31, 14, v31
    v_mul_u32_u24 v29, 12, v31
    v_sub_u32 v30, v30, v29
    v_mul_u32_u24 v31, 0xac0, v31
    v_lshl_add_u32 v16, v30, 4, v31
    v_cmp_lt_u32 vcc, 7, v30
    v_mov_b32 v29, s51
    s_nop 0
    v_cndmask_b32 v29, 0, v29, vcc
    v_add_u32 v16, v16, v29
    v_add_u32 v30, 128, v26
    v_mul_u32_u24 v31, 0x556, v30
    v_lshrrev_b32 v31, 14, v31
    v_mul_u32_u24 v29, 12, v31
    v_sub_u32 v30, v30, v29
    v_mul_u32_u24 v31, 0xac0, v31
    v_lshl_add_u32 v17, v30, 4, v31
    v_cmp_lt_u32 vcc, 7, v30
    v_mov_b32 v29, s51
    s_nop 0
    v_cndmask_b32 v29, 0, v29, vcc
    v_add_u32 v17, v17, v29
    s_lshl_b32 s48, s42, 17
    s_lshl_b32 s54, s41, 15
    s_add_u32 s48, s48, s54
    s_lshl_b32 s49, s43, 15
    s_and_b32 s55, s41, 1
    s_lshl_b32 s54, s55, 14
    s_add_u32 s49, s49, s54
    s_mul_i32 s50, s55, 44032
    s_lshl_b32 s54, s45, 6
    s_add_u32 s50, s50, s54
    s_lshl_b32 s56, s41, 12
    s_lshl_b32 s57, s41, 11
    s_add_u32 s57, s57, 65536
    s_mul_i32 s58, s41, 3072
    s_waitcnt lgkmcnt(0)
    s_mov_b32 s8, s64
    s_mov_b32 s9, s65
    s_mov_b32 s10, 2097152
    s_mov_b32 s11, 0x00020000
    s_cmp_lt_u32 s41, 2
    s_cselect_b32 s12, s70, s72
    s_cselect_b32 s13, s71, s73
    s_mov_b32 s14, 524288
    s_mov_b32 s15, 0x00020000
    s_cselect_b32 s16, s76, s78
    s_cselect_b32 s17, s77, s79
    s_mov_b32 s18, 1409024
    s_mov_b32 s19, 0x00020000
    s_mov_b32 s20, s82
    s_mov_b32 s21, s83
    s_mov_b32 s22, 16777216
    s_mov_b32 s23, 0x00020000
    s_add_u32 s84, s82, 12582912
    s_addc_u32 s85, s83, 0
    s_load_dword s46, s[84:85], 0
    s_cmp_ge_u32 s40, 4
    s_cbranch_scc1 F_Z
    s_mov_b32 s28, s66
    s_mov_b32 s29, s67
    s_mov_b32 s30, 1024
    s_mov_b32 s31, 0x00020000
    s_mov_b32 s32, s68
    s_mov_b32 s33, s69
    s_mov_b32 s34, 1024
    s_mov_b32 s35, 0x00020000
    s_mov_b32 s36, s74
    s_mov_b32 s37, s75
    s_mov_b32 s38, 1024
    s_mov_b32 s39, 0x00020000
    v_and_b32 v27, 31, v26
    s_lshl_b32 s52, s43, 6
    v_lshl_add_u32 v27, v27, 1, s52
    buffer_load_ushort v32, v27, s[28:31], 0 offen
    buffer_load_ushort v33, v27, s[32:35], 0 offen
    buffer_load_ushort v34, v27, s[36:39], 0 offen
    s_add_u32 s60, s101, 0
    s_and_b32 s60, s60, 7
    s_lshl_b32 s60, s60, 7
    s_add_u32 s61, s60, s48
    s_add_u32 m0, s56, 0
    s_add_u32 s63, s61, 0
    buffer_load_dwordx4 v11, s[8:11], s63 offen  lds
    s_add_u32 m0, s56, 1024
    s_add_u32 s63, s61, 4096
    buffer_load_dwordx4 v12, s[8:11], s63 offen  lds
    s_add_u32 m0, s57, 0
    s_add_u32 s63, s60, s49
    buffer_load_dwordx4 v13, s[12:15], s63 offen  lds
    s_add_u32 m0, s57, 1024
    s_add_u32 s63, s60, s49
    s_add_u32 s63, s63, 8192
    buffer_load_dwordx4 v14, s[12:15], s63 offen  lds
    s_lshl_b32 s47, s43, 1
    s_lshr_b32 s54, s42, 3
    s_add_u32 s47, s47, s54
    s_lshl_b32 s47, s47, 14
    s_add_u32 s47, s47, 12058624
    s_lshl_b32 s98, s42, 2
    s_lshr_b32 s54, s43, 2
    s_add_u32 s98, s98, s54
    s_lshl_b32 s98, s98, 2
    s_add_u32 s98, s98, s41
    s_lshl_b32 s98, s98, 11
    s_add_u32 s98, s98, 11010048
    v_lshrrev_b32 v29, 5, v26
    v_and_b32 v30, 31, v26
    v_bfe_u32 v31, v26, 1, 3
    v_xor_b32 v31, v31, v29
    v_lshlrev_b32 v31, 4, v31
    v_lshl_add_u32 v30, v30, 7, v31
    v_add_u32 v1, s56, v30
    v_add_u32 v5, 65536, v30
    v_xor_b32 v2, 32, v1
    v_xor_b32 v6, 32, v5
    v_xor_b32 v3, 64, v1
    v_xor_b32 v7, 64, v5
    v_xor_b32 v4, 96, v1
    v_xor_b32 v8, 96, v5
    v_bfe_u32 v30, v26, 2, 2
    v_lshl_add_u32 v30, v29, 3, v30
    v_mul_u32_u24 v30, 192, v30
    v_bfe_u32 v31, v26, 4, 1
    v_lshl_add_u32 v30, v31, 5, v30
    v_and_b32 v31, 3, v26
    v_lshl_add_u32 v10, v31, 3, v30
    v_add_u32 v9, 86016, v10
    v_mov_b32 v22, s59
    v_mov_b32 v23, 0x3f803f80
    v_mov_b32 v18, 0
    v_mov_b32 v19, 0
    v_mov_b32 v20, 0
    v_mov_b32 v21, 0
    v_mov_b32 v24, 0
    v_mov_b32 v25, 0
    v_mov_b32 v64, 0
    v_mov_b32 v65, 0
    v_mov_b32 v66, 0
    v_mov_b32 v67, 0
    v_mov_b32 v68, 0
    v_mov_b32 v69, 0
    v_mov_b32 v70, 0
    v_mov_b32 v71, 0
    v_mov_b32 v72, 0
    v_mov_b32 v73, 0
    v_mov_b32 v74, 0
    v_mov_b32 v75, 0
    v_mov_b32 v76, 0
    v_mov_b32 v77, 0
    v_mov_b32 v78, 0
    v_mov_b32 v79, 0
    v_mov_b32 v80, 0
    v_mov_b32 v81, 0
    v_mov_b32 v82, 0
    v_mov_b32 v83, 0
    v_mov_b32 v84, 0
    v_mov_b32 v85, 0
    v_mov_b32 v86, 0
    v_mov_b32 v87, 0
    v_mov_b32 v88, 0
    v_mov_b32 v89, 0
    v_mov_b32 v90, 0
    v_mov_b32 v91, 0
    v_mov_b32 v92, 0
    v_mov_b32 v93, 0
    v_mov_b32 v94, 0
    v_mov_b32 v95, 0
    v_mov_b32 v96, 0
    v_mov_b32 v97, 0
    v_mov_b32 v98, 0
    v_mov_b32 v99, 0
    v_mov_b32 v100, 0
    v_mov_b32 v101, 0
    v_mov_b32 v102, 0
    v_mov_b32 v103, 0
    v_mov_b32 v104, 0
    v_mov_b32 v105, 0
    v_mov_b32 v106, 0
    v_mov_b32 v107, 0
    v_mov_b32 v108, 0
    v_mov_b32 v109, 0
    v_mov_b32 v110, 0
    v_mov_b32 v111, 0
    v_mov_b32 v112, 0
    v_mov_b32 v113, 0
    v_mov_b32 v114, 0
    v_mov_b32 v115, 0
    v_mov_b32 v116, 0
    v_mov_b32 v117, 0
    v_mov_b32 v118, 0
    v_mov_b32 v119, 0
    v_mov_b32 v120, 0
    v_mov_b32 v121, 0
    v_mov_b32 v122, 0
    v_mov_b32 v123, 0
    v_mov_b32 v124, 0
    v_mov_b32 v125, 0
    v_mov_b32 v126, 0
    v_mov_b32 v127, 0
    s_add_u32 s60, s101, 1
    s_and_b32 s60, s60, 7
    s_lshl_b32 s60, s60, 7
    s_add_u32 s61, s60, s48
    s_add_u32 m0, s56, 16384
    s_add_u32 s63, s61, 0
    buffer_load_dwordx4 v11, s[8:11], s63 offen  lds
    s_add_u32 m0, s56, 17408
    s_add_u32 s63, s61, 4096
    buffer_load_dwordx4 v12, s[8:11], s63 offen  lds
    s_add_u32 m0, s57, 8192
    s_add_u32 s63, s60, s49
    buffer_load_dwordx4 v13, s[12:15], s63 offen  lds
    s_add_u32 m0, s57, 9216
    s_add_u32 s63, s60, s49
    s_add_u32 s63, s63, 8192
    buffer_load_dwordx4 v14, s[12:15], s63 offen  lds
    s_waitcnt lgkmcnt(0)
    s_mul_i32 s46, s46, 0x9E3779B1
    s_add_u32 s46, s46, 0x7F4A7C15
    s_and_b32 s52, s2, 7
    s_lshr_b32 s53, s2, 3
    s_and_b32 s54, s53, 3
    s_lshl_b32 s84, s52, 2
    s_add_u32 s84, s84, s54
    s_lshr_b32 s85, s53, 2
    s_waitcnt vmcnt(8)
    v_lshlrev_b32 v36, 16, v32
    v_lshlrev_b32 v37, 16, v33
    v_lshlrev_b32 v38, 16, v34
    v_mul_f32 v38, 0x3fb8aa3b, v38
    v_exp_f32 v38, v38
    s_nop 0
    v_cvt_pk_bf16_f32 v38, v38, v38
    v_and_b32 v38, s59, v38
    v_mul_f32 v39, v38, v36
    v_mul_f32 v40, v38, v37
    v_mul_f32 v39, 0x3fb8aa3b, v39
    v_mul_f32 v40, 0.15915494309189535, v40
    v_lshrrev_b32 v41, 5, v26
    s_lshl_b32 s52, s41, 1
    v_add_u32 v41, s52, v41
    s_sub_u32 s52, s42, 1
    v_sub_u32 v45, s52, v41
    v_subrev_u32 v46, 8, v45
    v_max_i32 v45, 0, v45
    v_max_i32 v46, 0, v46
    v_lshlrev_b32 v45, 7, v45
    v_lshlrev_b32 v46, 7, v46
    v_cvt_f32_u32 v45, v45
    v_cvt_f32_u32 v46, v46
    v_and_b32 v27, 31, v26
    v_lshl_add_u32 v28, v41, 5, v27
    v_mul_u32_u24 v28, 24, v28
    v_add_u32 v28, 151040, v28
    v_lshlrev_b32 v41, 4, v41
    v_cvt_f32_u32 v41, v41
    v_mul_f32 v42, 1.0, v39
    v_mul_f32 v43, 1.0, v40
    v_exp_f32 v42, v42
    v_fract_f32 v43, v43
    v_cos_f32 v48, v43
    v_sin_f32 v49, v43
    v_mul_f32 v48, v48, v42
    v_mul_f32 v49, v49, v42
    v_mul_f32 v42, 0x41800000, v39
    v_mul_f32 v43, 0x41800000, v40
    v_exp_f32 v42, v42
    v_fract_f32 v43, v43
    v_cos_f32 v50, v43
    v_sin_f32 v51, v43
    v_mul_f32 v50, v50, v42
    v_mul_f32 v51, v51, v42
    v_mul_f32 v42, v41, v39
    v_mul_f32 v43, v41, v40
    v_exp_f32 v42, v42
    v_fract_f32 v43, v43
    v_cos_f32 v54, v43
    v_sin_f32 v55, v43
    v_mul_f32 v54, v54, v42
    v_mul_f32 v55, v55, v42
    v_mul_f32 v42, v45, v39
    v_mul_f32 v43, v45, v40
    v_exp_f32 v42, v42
    v_fract_f32 v43, v43
    v_cos_f32 v56, v43
    v_sin_f32 v57, v43
    v_mul_f32 v56, v56, v42
    v_mul_f32 v57, v57, v42
    v_mul_f32 v42, v46, v39
    v_mul_f32 v43, v46, v40
    v_exp_f32 v42, v42
    v_fract_f32 v43, v43
    v_cos_f32 v58, v43
    v_sin_f32 v59, v43
    v_mul_f32 v58, v58, v42
    v_mul_f32 v59, v59, v42
    v_mul_f32 v44, v36, v36
    v_fmac_f32 v44, v37, v37
    v_rcp_f32 v44, v44
    v_add_f32 v42, -1.0, v48
    v_mul_f32 v52, v42, v36
    v_fmac_f32 v52, v49, v37
    v_mul_f32 v53, v49, v36
    v_fma_f32 v53, -v42, v37, v53
    v_add_f32 v44, v44, v44
    v_mul_f32 v52, v52, v44
    v_mul_f32 v53, v53, v44
    v_lshlrev_b32 v29, 5, v27
    v_add_u32 v29, 150016, v29
    ds_write_b128 v29, v[48:51]
    ds_write_b64 v29, v[52:53] offset:16
    ds_write_b64 v28, v[54:55] offset:0
    ds_write_b64 v28, v[56:57] offset:8
    ds_write_b64 v28, v[58:59] offset:16
    s_lshl_b32 s36, s41, 8
    s_add_u32 s36, s36, s2
    v_lshrrev_b32 v29, 3, v26
    v_and_b32 v30, 7, v26
    s_lshl_b32 s55, s41, 12
    s_add_u32 s55, s55, 135168
    s_mov_b32 s31, 0x00020000
    s_cmp_ge_u32 s36, 344
    s_cbranch_scc1 F_RL_C
    s_mul_i32 s52, s36, 1525
    s_lshr_b32 s52, s52, 16
    s_mul_i32 s53, s52, 43
    s_sub_u32 s53, s36, s53
    s_lshl_b32 s37, s53, 15
    s_lshl_b32 s52, s52, 7
    s_add_u32 s37, s37, s52
    s_mov_b32 s28, s24
    s_mov_b32 s29, s25
    s_mov_b32 s30, 1409024
    v_bfe_u32 v27, v29, 1, 1
    v_lshlrev_b32 v27, 2, v27
    v_xor_b32 v27, v27, v30
    v_lshlrev_b32 v27, 4, v27
    v_lshl_add_u32 v27, v29, 10, v27
    v_mov_b32 v28, v27
    s_branch F_RL_J
F_RL_C:
    s_sub_u32 s52, s36, 344
    s_lshr_b32 s53, s52, 5
    s_lshl_b32 s37, s53, 16
    s_and_b32 s53, s52, 1
    s_lshl_b32 s53, s53, 15
    s_add_u32 s37, s37, s53
    s_bfe_u32 s53, s52, 0x30001
    s_lshl_b32 s53, s53, 7
    s_add_u32 s37, s37, s53
    s_bitcmp1_b32 s52, 4
    s_cselect_b32 s28, s6, s4
    s_cselect_b32 s29, s7, s5
    s_mov_b32 s30, 524288
    s_cmp_ge_u32 s36, 600
    s_cselect_b32 s37, 1073741824, s37
    v_mov_b32 v27, v13
    v_mov_b32 v28, v14
F_RL_J:
    s_cmp_eq_u32 s41, 3
    s_cselect_b32 s55, 163840, s55
    s_add_u32 m0, s55, 0
    s_add_u32 s52, s37, 0
    buffer_load_dwordx4 v27, s[28:31], s52 offen lds
    s_add_u32 m0, s55, 1024
    s_add_u32 s52, s37, 8192
    buffer_load_dwordx4 v28, s[28:31], s52 offen lds
    s_add_u32 m0, s55, 2048
    s_add_u32 s52, s37, 16384
    buffer_load_dwordx4 v27, s[28:31], s52 offen lds
    s_add_u32 m0, s55, 3072
    s_add_u32 s52, s37, 24576
    buffer_load_dwordx4 v28, s[28:31], s52 offen lds
    s_waitcnt vmcnt(8)
    s_waitcnt lgkmcnt(0)
    s_barrier
    ds_read_b128 a[0:3], v1 offset:0
    ds_read_b128 v[32:35], v5 offset:0
    ds_read_b128 v[36:39], v5 offset:4096
    ds_read_b128 a[4:7], v2 offset:0
    ds_read_b128 v[40:43], v6 offset:0
    ds_read_b128 v[44:47], v6 offset:4096
    ds_read_b128 a[8:11], v3 offset:0
    ds_read_b128 v[48:51], v7 offset:0
    ds_read_b128 v[52:55], v7 offset:4096
    ds_read_b128 a[12:15], v4 offset:0
    ds_read_b128 v[56:59], v8 offset:0
    ds_read_b128 v[60:63], v8 offset:4096
    s_add_u32 s60, s101, 2
    s_and_b32 s60, s60, 7
    s_lshl_b32 s60, s60, 7
    s_add_u32 s61, s60, s48
    s_add_u32 m0, s56, 32768
    s_add_u32 s63, s61, 0
    buffer_load_dwordx4 v11, s[8:11], s63 offen  lds
    s_add_u32 m0, s56, 33792
    s_add_u32 s63, s61, 4096
    buffer_load_dwordx4 v12, s[8:11], s63 offen  lds
    s_add_u32 m0, s56, 34816
    s_add_u32 s63, s61, 8192
    buffer_load_dwordx4 v11, s[8:11], s63 offen  lds
    s_add_u32 m0, s56, 35840
    s_add_u32 s63, s61, 12288
    buffer_load_dwordx4 v12, s[8:11], s63 offen  lds
    s_add_u32 m0, s57, 16384
    s_add_u32 s63, s60, s49
    buffer_load_dwordx4 v13, s[12:15], s63 offen  lds
    s_add_u32 m0, s57, 17408
    s_add_u32 s63, s60, s49
    s_add_u32 s63, s63, 8192
    buffer_load_dwordx4 v14, s[12:15], s63 offen  lds
    s_waitcnt lgkmcnt(9)
    v_mfma_f32_32x32x16_bf16 v[64:79], a[0:3], v[32:35], v[64:79]
    v_mfma_f32_32x32x16_bf16 v[80:95], a[0:3], v[36:39], v[80:95]
    s_cmp_eq_u32 s41, 2
    s_cbranch_scc0 F_cb1
    v_dot2c_f32_bf16 v24, v23, v32
    v_dot2c_f32_bf16 v25, v23, v33
    v_dot2c_f32_bf16 v24, v23, v34
    v_dot2c_f32_bf16 v25, v23, v35
F_cb1:
    s_cmp_eq_u32 s41, 3
    s_cbranch_scc0 F_cb2
    v_dot2c_f32_bf16 v24, v23, v36
    v_dot2c_f32_bf16 v25, v23, v37
    v_dot2c_f32_bf16 v24, v23, v38
    v_dot2c_f32_bf16 v25, v23, v39
F_cb2:
    ds_read_b64_tr_b16 v[32:33], v9 offset:12288
    ds_read_b64_tr_b16 v[34:35], v9 offset:13056
    ds_read_b64_tr_b16 v[36:37], v9 offset:18432
    ds_read_b64_tr_b16 v[38:39], v9 offset:19200
    s_add_u32 s60, s101, 3
    s_and_b32 s60, s60, 7
    s_lshl_b32 s60, s60, 7
    s_add_u32 s61, s60, s48
    s_add_u32 m0, s56, 49152
    s_add_u32 s63, s61, 0
    buffer_load_dwordx4 v11, s[8:11], s63 offen  lds
    s_add_u32 m0, s56, 50176
    s_add_u32 s63, s61, 4096
    buffer_load_dwordx4 v12, s[8:11], s63 offen  lds
    s_add_u32 m0, s56, 51200
    s_add_u32 s63, s61, 8192
    buffer_load_dwordx4 v11, s[8:11], s63 offen  lds
    s_add_u32 m0, s56, 52224
    s_add_u32 s63, s61, 12288
    buffer_load_dwordx4 v12, s[8:11], s63 offen  lds
    s_add_u32 m0, s57, 24576
    s_add_u32 s63, s60, s49
    buffer_load_dwordx4 v13, s[12:15], s63 offen  lds
    s_add_u32 m0, s57, 25600
    s_add_u32 s63, s60, s49
    s_add_u32 s63, s63, 8192
    buffer_load_dwordx4 v14, s[12:15], s63 offen  lds
    s_waitcnt lgkmcnt(10)
    v_mfma_f32_32x32x16_bf16 v[64:79], a[4:7], v[40:43], v[64:79]
    v_mfma_f32_32x32x16_bf16 v[80:95], a[4:7], v[44:47], v[80:95]
    s_cmp_eq_u32 s41, 2
    s_cbranch_scc0 F_cb3
    v_dot2c_f32_bf16 v24, v23, v40
    v_dot2c_f32_bf16 v25, v23, v41
    v_dot2c_f32_bf16 v24, v23, v42
    v_dot2c_f32_bf16 v25, v23, v43
F_cb3:
    s_cmp_eq_u32 s41, 3
    s_cbranch_scc0 F_cb4
    v_dot2c_f32_bf16 v24, v23, v44
    v_dot2c_f32_bf16 v25, v23, v45
    v_dot2c_f32_bf16 v24, v23, v46
    v_dot2c_f32_bf16 v25, v23, v47
F_cb4:
    ds_read_b64_tr_b16 v[40:41], v9 offset:15360
    ds_read_b64_tr_b16 v[42:43], v9 offset:16128
    ds_read_b64_tr_b16 v[44:45], v9 offset:21504
    ds_read_b64_tr_b16 v[46:47], v9 offset:22272
    s_waitcnt lgkmcnt(11)
    v_mfma_f32_32x32x16_bf16 v[64:79], a[8:11], v[48:51], v[64:79]
    v_mfma_f32_32x32x16_bf16 v[80:95], a[8:11], v[52:55], v[80:95]
    s_cmp_eq_u32 s41, 2
    s_cbranch_scc0 F_cb5
    v_dot2c_f32_bf16 v24, v23, v48
    v_dot2c_f32_bf16 v25, v23, v49
    v_dot2c_f32_bf16 v24, v23, v50
    v_dot2c_f32_bf16 v25, v23, v51
F_cb5:
    s_cmp_eq_u32 s41, 3
    s_cbranch_scc0 F_cb6
    v_dot2c_f32_bf16 v24, v23, v52
    v_dot2c_f32_bf16 v25, v23, v53
    v_dot2c_f32_bf16 v24, v23, v54
    v_dot2c_f32_bf16 v25, v23, v55
F_cb6:
    s_waitcnt lgkmcnt(8)
    v_mfma_f32_32x32x16_bf16 v[64:79], a[12:15], v[56:59], v[64:79]
    v_mfma_f32_32x32x16_bf16 v[80:95], a[12:15], v[60:63], v[80:95]
    s_cmp_eq_u32 s41, 2
    s_cbranch_scc0 F_cb7
    v_dot2c_f32_bf16 v24, v23, v56
    v_dot2c_f32_bf16 v25, v23, v57
    v_dot2c_f32_bf16 v24, v23, v58
    v_dot2c_f32_bf16 v25, v23, v59
F_cb7:
    s_cmp_eq_u32 s41, 3
    s_cbranch_scc0 F_cb8
    v_dot2c_f32_bf16 v24, v23, v60
    v_dot2c_f32_bf16 v25, v23, v61
    v_dot2c_f32_bf16 v24, v23, v62
    v_dot2c_f32_bf16 v25, v23, v63
F_cb8:
    s_waitcnt vmcnt(16)
    s_waitcnt lgkmcnt(0)
    s_barrier
    ds_read_b128 a[16:19], v1 offset:16384
    ds_read_b128 v[48:51], v5 offset:8192
    ds_read_b128 v[52:55], v5 offset:12288
    ds_read_b128 a[20:23], v2 offset:16384
    ds_read_b128 v[56:59], v6 offset:8192
    ds_read_b128 v[60:63], v6 offset:12288
    ds_read_b128 a[24:27], v3 offset:16384
    s_add_u32 s60, s101, 4
    s_and_b32 s60, s60, 7
    s_lshl_b32 s60, s60, 7
    s_add_u32 s61, s60, s48
    s_add_u32 m0, s56, 0
    s_add_u32 s63, s61, 0
    buffer_load_dwordx4 v11, s[8:11], s63 offen  lds
    s_add_u32 m0, s56, 1024
    s_add_u32 s63, s61, 4096
    buffer_load_dwordx4 v12, s[8:11], s63 offen  lds
    v_mfma_f32_32x32x16_bf16 v[96:111], v[32:35], a[0:3], v[96:111]
    v_mfma_f32_32x32x16_bf16 v[112:127], v[36:39], a[0:3], v[112:127]
    s_cmp_eq_u32 s41, 0
    s_cbranch_scc0 F_cw9
    v_dot2c_f32_bf16 v24, v23, v32
    v_dot2c_f32_bf16 v25, v23, v33
    v_dot2c_f32_bf16 v24, v23, v34
    v_dot2c_f32_bf16 v25, v23, v35
F_cw9:
    s_cmp_eq_u32 s41, 1
    s_cbranch_scc0 F_cw10
    v_dot2c_f32_bf16 v24, v23, v36
    v_dot2c_f32_bf16 v25, v23, v37
    v_dot2c_f32_bf16 v24, v23, v38
    v_dot2c_f32_bf16 v25, v23, v39
F_cw10:
    ds_read_b128 v[32:35], v7 offset:8192
    ds_read_b128 v[36:39], v7 offset:12288
    ds_read_b128 a[28:31], v4 offset:16384
    s_add_u32 m0, s56, 2048
    s_add_u32 s63, s61, 8192
    buffer_load_dwordx4 v11, s[8:11], s63 offen  lds
    s_add_u32 m0, s56, 3072
    s_add_u32 s63, s61, 12288
    buffer_load_dwordx4 v12, s[8:11], s63 offen  lds
    v_mfma_f32_32x32x16_bf16 v[96:111], v[40:43], a[4:7], v[96:111]
    v_mfma_f32_32x32x16_bf16 v[112:127], v[44:47], a[4:7], v[112:127]
    s_cmp_eq_u32 s41, 0
    s_cbranch_scc0 F_cw11
    v_dot2c_f32_bf16 v24, v23, v40
    v_dot2c_f32_bf16 v25, v23, v41
    v_dot2c_f32_bf16 v24, v23, v42
    v_dot2c_f32_bf16 v25, v23, v43
F_cw11:
    s_cmp_eq_u32 s41, 1
    s_cbranch_scc0 F_cw12
    v_dot2c_f32_bf16 v24, v23, v44
    v_dot2c_f32_bf16 v25, v23, v45
    v_dot2c_f32_bf16 v24, v23, v46
    v_dot2c_f32_bf16 v25, v23, v47
F_cw12:
    ds_read_b128 v[40:43], v8 offset:8192
    ds_read_b128 v[44:47], v8 offset:12288
    s_add_u32 m0, s57, 0
    s_add_u32 s63, s60, s49
    buffer_load_dwordx4 v13, s[12:15], s63 offen  lds
    s_waitcnt lgkmcnt(9)
    v_mfma_f32_32x32x16_bf16 v[64:79], a[16:19], v[48:51], v[64:79]
    v_mfma_f32_32x32x16_bf16 v[80:95], a[16:19], v[52:55], v[80:95]
    ds_read_b64_tr_b16 v[48:49], v9 offset:24576
    ds_read_b64_tr_b16 v[50:51], v9 offset:25344
    ds_read_b64_tr_b16 v[52:53], v9 offset:30720
    ds_read_b64_tr_b16 v[54:55], v9 offset:31488
    s_add_u32 m0, s57, 1024
    s_add_u32 s63, s60, s49
    s_add_u32 s63, s63, 8192
    buffer_load_dwordx4 v14, s[12:15], s63 offen  lds
    s_waitcnt lgkmcnt(10)
    v_mfma_f32_32x32x16_bf16 v[64:79], a[20:23], v[56:59], v[64:79]
    v_mfma_f32_32x32x16_bf16 v[80:95], a[20:23], v[60:63], v[80:95]
    ds_read_b64_tr_b16 v[56:57], v9 offset:27648
    ds_read_b64_tr_b16 v[58:59], v9 offset:28416
    ds_read_b64_tr_b16 v[60:61], v9 offset:33792
    ds_read_b64_tr_b16 v[62:63], v9 offset:34560
    s_waitcnt lgkmcnt(11)
    v_mfma_f32_32x32x16_bf16 v[64:79], a[24:27], v[32:35], v[64:79]
    v_mfma_f32_32x32x16_bf16 v[80:95], a[24:27], v[36:39], v[80:95]
    s_waitcnt lgkmcnt(8)
    v_mfma_f32_32x32x16_bf16 v[64:79], a[28:31], v[40:43], v[64:79]
    v_mfma_f32_32x32x16_bf16 v[80:95], a[28:31], v[44:47], v[80:95]
    s_waitcnt lgkmcnt(4)
    v_mfma_f32_32x32x16_bf16 v[96:111], v[48:51], a[8:11], v[96:111]
    v_mfma_f32_32x32x16_bf16 v[112:127], v[52:55], a[8:11], v[112:127]
    s_cmp_eq_u32 s41, 0
    s_cbranch_scc0 F_cw13
    v_dot2c_f32_bf16 v24, v23, v48
    v_dot2c_f32_bf16 v25, v23, v49
    v_dot2c_f32_bf16 v24, v23, v50
    v_dot2c_f32_bf16 v25, v23, v51
F_cw13:
    s_cmp_eq_u32 s41, 1
    s_cbranch_scc0 F_cw14
    v_dot2c_f32_bf16 v24, v23, v52
    v_dot2c_f32_bf16 v25, v23, v53
    v_dot2c_f32_bf16 v24, v23, v54
    v_dot2c_f32_bf16 v25, v23, v55
F_cw14:
    s_waitcnt lgkmcnt(0)
    v_mfma_f32_32x32x16_bf16 v[96:111], v[56:59], a[12:15], v[96:111]
    v_mfma_f32_32x32x16_bf16 v[112:127], v[60:63], a[12:15], v[112:127]
    s_cmp_eq_u32 s41, 0
    s_cbranch_scc0 F_cw15
    v_dot2c_f32_bf16 v24, v23, v56
    v_dot2c_f32_bf16 v25, v23, v57
    v_dot2c_f32_bf16 v24, v23, v58
    v_dot2c_f32_bf16 v25, v23, v59
F_cw15:
    s_cmp_eq_u32 s41, 1
    s_cbranch_scc0 F_cw16
    v_dot2c_f32_bf16 v24, v23, v60
    v_dot2c_f32_bf16 v25, v23, v61
    v_dot2c_f32_bf16 v24, v23, v62
    v_dot2c_f32_bf16 v25, v23, v63
F_cw16:
    s_lshl_b32 s55, s41, 12
    s_add_u32 s55, s55, 135168
    v_lshrrev_b32 v31, 5, v26
    s_waitcnt vmcnt(18)
    s_cmp_ge_u32 s36, 344
    s_cbranch_scc1 F_RS_C
    v_bfe_u32 v27, v26, 2, 2
    v_lshl_add_u32 v27, v31, 2, v27
    v_lshlrev_b32 v27, 7, v27
    v_bfe_u32 v28, v26, 3, 1
    v_lshl_add_u32 v27, v28, 6, v27
    v_bfe_u32 v28, v26, 4, 1
    v_lshl_add_u32 v27, v28, 5, v27
    v_and_b32 v28, 3, v26
    v_lshl_add_u32 v27, v28, 3, v27
    v_add_u32 v27, s55, v27
    v_xor_b32 v28, 64, v27
    ds_read_b64_tr_b16 v[32:33], v27 offset:0
    ds_read_b64_tr_b16 v[34:35], v27 offset:1024
    ds_read_b64_tr_b16 v[36:37], v28 offset:0
    ds_read_b64_tr_b16 v[38:39], v28 offset:1024
    ds_read_b64_tr_b16 v[40:41], v27 offset:2048
    ds_read_b64_tr_b16 v[42:43], v27 offset:3072
    ds_read_b64_tr_b16 v[44:45], v28 offset:2048
    ds_read_b64_tr_b16 v[46:47], v28 offset:3072
    s_branch F_RS_J
F_RS_C:
    s_sub_u32 s55, s55, 65536
    v_add_u32 v27, s55, v5
    ds_read_b128 v[32:35], v27
    v_add_u32 v27, s55, v6
    ds_read_b128 v[36:39], v27
    v_add_u32 v27, s55, v7
    ds_read_b128 v[40:43], v27
    v_add_u32 v27, s55, v8
    ds_read_b128 v[44:47], v27
F_RS_J:
    v_lshlrev_b32 v27, 4, v26
    s_lshl_b32 s52, s36, 12
    s_add_u32 s52, s52, 13631488
    s_cmp_ge_u32 s36, 600
    s_cselect_b32 s52, 1073741824, s52
    s_waitcnt lgkmcnt(0)
    buffer_store_dwordx4 v[32:35], v27, s[20:23], s52 offen offset:0 sc1
    buffer_store_dwordx4 v[36:39], v27, s[20:23], s52 offen offset:1024 sc1
    buffer_store_dwordx4 v[40:43], v27, s[20:23], s52 offen offset:2048 sc1
    buffer_store_dwordx4 v[44:47], v27, s[20:23], s52 offen offset:3072 sc1
    s_nop 1
    s_waitcnt vmcnt(16)
    s_barrier
    s_lshl_b32 s52, s41, 10
    s_add_u32 s52, s52, 158272
    v_lshl_add_u32 v27, v26, 4, s52
    ds_read_b128 v[18:21], v27
    v_add_f32 v24, v24, v25
    v_mov_b32 v25, v24
    s_nop 1
    v_permlane32_swap_b32 v24, v25
    v_add_f32 v24, v24, v25
    v_mov_b32 v25, s46
    s_bfe_u32 s53, s44, 0x10001
    s_lshl_b32 s55, s53, 10
    s_lshr_b32 s53, s44, 2
    s_lshl_b32 s53, s53, 9
    s_add_u32 s55, s55, s53
    s_and_b32 s53, s44, 1
    s_lshl_b32 s53, s53, 3
    s_add_u32 s55, s55, s53
    v_lshlrev_b32 v27, 4, v26
    v_mov_b32 v28, 1073741824
    v_cmp_gt_u32 vcc, 32, v26
    s_nop 1
    v_cndmask_b32 v27, v28, v27, vcc
    s_add_u32 s53, s41, 4
    s_cmp_lt_u32 s41, 2
    s_cselect_b32 s54, s41, s53
    s_lshl_b32 s52, s54, 11
    s_add_u32 s52, s52, s47
    s_add_u32 s52, s52, s55
    buffer_store_dwordx2 v[24:25], v27, s[20:23], s52 offen sc1
    s_add_u32 s53, s41, 2
    s_lshl_b32 s52, s53, 11
    s_add_u32 s52, s52, s47
    s_add_u32 s52, s52, s55
    s_waitcnt lgkmcnt(0)
    v_mov_b32 v21, s46
    buffer_store_dwordx2 v[20:21], v27, s[20:23], s52 offen sc1
    s_lshl_b32 s54, s54, 11
    s_add_u32 s47, s47, s54
    s_and_b32 s52, s43, 1
    s_lshl_b32 s52, s52, 10
    s_bfe_u32 s53, s43, 0x10001
    s_lshl_b32 s53, s53, 9
    s_add_u32 s52, s52, s53
    s_add_u32 s52, s52, s98
    v_mov_b32 v20, v19
    v_mov_b32 v19, s46
    buffer_store_dwordx4 v[18:21], v27, s[20:23], s52 offen sc1
    ds_read_b128 a[32:35], v1 offset:32768
    ds_read_b128 v[48:51], v5 offset:16384
    ds_read_b128 v[52:55], v5 offset:20480
    ds_read_b128 a[36:39], v2 offset:32768
    ds_read_b128 v[56:59], v6 offset:16384
    ds_read_b128 v[60:63], v6 offset:20480
    ds_read_b128 a[40:43], v3 offset:32768
    ds_read_b128 v[32:35], v7 offset:16384
    ds_read_b128 v[36:39], v7 offset:20480
    ds_read_b128 a[44:47], v4 offset:32768
    ds_read_b128 v[40:43], v8 offset:16384
    ds_read_b128 v[44:47], v8 offset:20480
    s_waitcnt lgkmcnt(9)
    v_mfma_f32_32x32x16_bf16 v[64:79], a[32:35], v[48:51], v[64:79]
    v_mfma_f32_32x32x16_bf16 v[80:95], a[32:35], v[52:55], v[80:95]
    s_waitcnt lgkmcnt(6)
    v_mfma_f32_32x32x16_bf16 v[64:79], a[36:39], v[56:59], v[64:79]
    v_mfma_f32_32x32x16_bf16 v[80:95], a[36:39], v[60:63], v[80:95]
    s_waitcnt vmcnt(13)
    s_waitcnt lgkmcnt(0)
    s_barrier
    ds_read_b128 a[48:51], v1 offset:49152
    ds_read_b128 v[48:51], v5 offset:24576
    ds_read_b128 v[52:55], v5 offset:28672
    ds_read_b128 a[52:55], v2 offset:49152
    ds_read_b128 v[56:59], v6 offset:24576
    ds_read_b128 v[60:63], v6 offset:28672
    ds_read_b128 a[56:59], v3 offset:49152
    v_mfma_f32_32x32x16_bf16 v[64:79], a[40:43], v[32:35], v[64:79]
    v_mfma_f32_32x32x16_bf16 v[80:95], a[40:43], v[36:39], v[80:95]
    ds_read_b128 v[32:35], v7 offset:24576
    ds_read_b128 v[36:39], v7 offset:28672
    ds_read_b128 a[60:63], v4 offset:49152
    v_mfma_f32_32x32x16_bf16 v[64:79], a[44:47], v[40:43], v[64:79]
    v_mfma_f32_32x32x16_bf16 v[80:95], a[44:47], v[44:47], v[80:95]
    ds_read_b128 v[40:43], v8 offset:24576
    ds_read_b128 v[44:47], v8 offset:28672
    s_waitcnt lgkmcnt(9)
    v_mfma_f32_32x32x16_bf16 v[64:79], a[48:51], v[48:51], v[64:79]
    v_mfma_f32_32x32x16_bf16 v[80:95], a[48:51], v[52:55], v[80:95]
    s_waitcnt lgkmcnt(6)
    v_mfma_f32_32x32x16_bf16 v[64:79], a[52:55], v[56:59], v[64:79]
    v_mfma_f32_32x32x16_bf16 v[80:95], a[52:55], v[60:63], v[80:95]
    s_waitcnt vmcnt(7)
    s_waitcnt lgkmcnt(0)
    s_barrier
    ds_read_b128 a[64:67], v1 offset:0
    ds_read_b128 v[48:51], v5 offset:0
    ds_read_b128 v[52:55], v5 offset:4096
    ds_read_b128 a[68:71], v2 offset:0
    ds_read_b128 v[56:59], v6 offset:0
    ds_read_b128 v[60:63], v6 offset:4096
    ds_read_b128 a[72:75], v3 offset:0
    v_mfma_f32_32x32x16_bf16 v[64:79], a[56:59], v[32:35], v[64:79]
    v_mfma_f32_32x32x16_bf16 v[80:95], a[56:59], v[36:39], v[80:95]
    ds_read_b128 v[32:35], v7 offset:0
    ds_read_b128 v[36:39], v7 offset:4096
    ds_read_b128 a[76:79], v4 offset:0
    v_mfma_f32_32x32x16_bf16 v[64:79], a[60:63], v[40:43], v[64:79]
    v_mfma_f32_32x32x16_bf16 v[80:95], a[60:63], v[44:47], v[80:95]
    ds_read_b128 v[40:43], v8 offset:0
    ds_read_b128 v[44:47], v8 offset:4096
    s_waitcnt lgkmcnt(9)
    v_mfma_f32_32x32x16_bf16 v[64:79], a[64:67], v[48:51], v[64:79]
    v_mfma_f32_32x32x16_bf16 v[80:95], a[64:67], v[52:55], v[80:95]
    s_waitcnt lgkmcnt(6)
    v_mfma_f32_32x32x16_bf16 v[64:79], a[68:71], v[56:59], v[64:79]
    v_mfma_f32_32x32x16_bf16 v[80:95], a[68:71], v[60:63], v[80:95]
    s_waitcnt lgkmcnt(0)
    s_barrier
    s_waitcnt vmcnt(3)
    s_lshl_b32 s52, s36, 2
    s_add_u32 s52, s52, 10616832
    s_cmp_ge_u32 s36, 600
    s_cselect_b32 s52, 1073741824, s52
    v_mov_b32 v30, 1073741824
    v_cmp_eq_u32 vcc, 0, v26
    v_mov_b32 v31, s46
    s_nop 0
    v_cndmask_b32 v30, v30, 0, vcc
    buffer_store_dword v31, v30, s[20:23], s52 offen sc1
    ds_read_b128 a[80:83], v1 offset:16384
    ds_read_b128 v[48:51], v5 offset:8192
    ds_read_b128 v[52:55], v5 offset:12288
    ds_read_b128 a[84:87], v2 offset:16384
    ds_read_b128 v[56:59], v6 offset:8192
    ds_read_b128 v[60:63], v6 offset:12288
    ds_read_b128 a[88:91], v3 offset:16384
    v_mfma_f32_32x32x16_bf16 v[64:79], a[72:75], v[32:35], v[64:79]
    v_mfma_f32_32x32x16_bf16 v[80:95], a[72:75], v[36:39], v[80:95]
    ds_read_b128 v[32:35], v7 offset:8192
    ds_read_b128 v[36:39], v7 offset:12288
    ds_read_b128 a[92:95], v4 offset:16384
    v_mfma_f32_32x32x16_bf16 v[64:79], a[76:79], v[40:43], v[64:79]
    v_mfma_f32_32x32x16_bf16 v[80:95], a[76:79], v[44:47], v[80:95]
    ds_read_b128 v[40:43], v8 offset:8192
    ds_read_b128 v[44:47], v8 offset:12288
    s_waitcnt lgkmcnt(9)
    v_mfma_f32_32x32x16_bf16 v[64:79], a[80:83], v[48:51], v[64:79]
    v_mfma_f32_32x32x16_bf16 v[80:95], a[80:83], v[52:55], v[80:95]
    s_waitcnt lgkmcnt(6)
    v_mfma_f32_32x32x16_bf16 v[64:79], a[84:87], v[56:59], v[64:79]
    v_mfma_f32_32x32x16_bf16 v[80:95], a[84:87], v[60:63], v[80:95]
    s_waitcnt lgkmcnt(0)
    s_barrier
    v_lshlrev_b32 v27, 4, v26
    buffer_load_dwordx4 a[0:3], v27, s[20:23], s47 offen offset:0 sc1
    buffer_load_dwordx4 a[4:7], v27, s[20:23], s47 offen offset:1024 sc1
    buffer_load_dwordx4 a[8:11], v27, s[20:23], s98 offen offset:0 sc1
    buffer_load_dwordx4 a[12:15], v27, s[20:23], s98 offen offset:1024 sc1
    ds_read_b128 a[96:99], v1 offset:32768
    ds_read_b128 v[48:51], v5 offset:16384
    ds_read_b128 v[52:55], v5 offset:20480
    ds_read_b128 a[100:103], v2 offset:32768
    ds_read_b128 v[56:59], v6 offset:16384
    ds_read_b128 v[60:63], v6 offset:20480
    ds_read_b128 a[104:107], v3 offset:32768
    v_mfma_f32_32x32x16_bf16 v[64:79], a[88:91], v[32:35], v[64:79]
    v_mfma_f32_32x32x16_bf16 v[80:95], a[88:91], v[36:39], v[80:95]
    ds_read_b128 v[32:35], v7 offset:16384
    ds_read_b128 v[36:39], v7 offset:20480
    ds_read_b128 a[108:111], v4 offset:32768
    v_mfma_f32_32x32x16_bf16 v[64:79], a[92:95], v[40:43], v[64:79]
    v_mfma_f32_32x32x16_bf16 v[80:95], a[92:95], v[44:47], v[80:95]
    ds_read_b128 v[40:43], v8 offset:16384
    ds_read_b128 v[44:47], v8 offset:20480
    s_waitcnt lgkmcnt(9)
    v_mfma_f32_32x32x16_bf16 v[64:79], a[96:99], v[48:51], v[64:79]
    v_mfma_f32_32x32x16_bf16 v[80:95], a[96:99], v[52:55], v[80:95]
    s_waitcnt lgkmcnt(6)
    v_mfma_f32_32x32x16_bf16 v[64:79], a[100:103], v[56:59], v[64:79]
    v_mfma_f32_32x32x16_bf16 v[80:95], a[100:103], v[60:63], v[80:95]
    s_waitcnt lgkmcnt(0)
    s_barrier
    ds_read_b128 a[112:115], v1 offset:49152
    ds_read_b128 v[48:51], v5 offset:24576
    ds_read_b128 v[52:55], v5 offset:28672
    ds_read_b128 a[116:119], v2 offset:49152
    ds_read_b128 v[56:59], v6 offset:24576
    ds_read_b128 v[60:63], v6 offset:28672
    ds_read_b128 a[120:123], v3 offset:49152
    v_mfma_f32_32x32x16_bf16 v[64:79], a[104:107], v[32:35], v[64:79]
    v_mfma_f32_32x32x16_bf16 v[80:95], a[104:107], v[36:39], v[80:95]
    ds_read_b128 v[32:35], v7 offset:24576
    ds_read_b128 v[36:39], v7 offset:28672
    ds_read_b128 a[124:127], v4 offset:49152
    v_mfma_f32_32x32x16_bf16 v[64:79], a[108:111], v[40:43], v[64:79]
    v_mfma_f32_32x32x16_bf16 v[80:95], a[108:111], v[44:47], v[80:95]
    ds_read_b128 v[40:43], v8 offset:24576
    ds_read_b128 v[44:47], v8 offset:28672
    s_waitcnt lgkmcnt(9)
    v_mfma_f32_32x32x16_bf16 v[64:79], a[112:115], v[48:51], v[64:79]
    v_mfma_f32_32x32x16_bf16 v[80:95], a[112:115], v[52:55], v[80:95]
    s_waitcnt lgkmcnt(6)
    v_mfma_f32_32x32x16_bf16 v[64:79], a[116:119], v[56:59], v[64:79]
    v_mfma_f32_32x32x16_bf16 v[80:95], a[116:119], v[60:63], v[80:95]
    s_waitcnt lgkmcnt(3)
    v_mfma_f32_32x32x16_bf16 v[64:79], a[120:123], v[32:35], v[64:79]
    v_mfma_f32_32x32x16_bf16 v[80:95], a[120:123], v[36:39], v[80:95]
    s_waitcnt lgkmcnt(0)
    v_mfma_f32_32x32x16_bf16 v[64:79], a[124:127], v[40:43], v[64:79]
    v_mfma_f32_32x32x16_bf16 v[80:95], a[124:127], v[44:47], v[80:95]
    s_waitcnt vmcnt(0)
F_GAY:
    v_mov_b32 v31, 0
    v_accvgpr_read_b32 v32, a0
    v_accvgpr_read_b32 v33, a1
    v_accvgpr_read_b32 v34, a2
    v_accvgpr_read_b32 v35, a3
    v_accvgpr_read_b32 v36, a4
    v_accvgpr_read_b32 v37, a5
    v_accvgpr_read_b32 v38, a6
    v_accvgpr_read_b32 v39, a7
    v_xor_b32 v33, s46, v33
    v_xor_b32 v35, s46, v35
    v_xor_b32 v37, s46, v37
    v_xor_b32 v39, s46, v39
    v_or3_b32 v31, v31, v33, v35
    v_or3_b32 v31, v31, v37, v39
    v_accvgpr_read_b32 v40, a8
    v_accvgpr_read_b32 v41, a9
    v_accvgpr_read_b32 v42, a10
    v_accvgpr_read_b32 v43, a11
    v_accvgpr_read_b32 v44, a12
    v_accvgpr_read_b32 v45, a13
    v_accvgpr_read_b32 v46, a14
    v_accvgpr_read_b32 v47, a15
    v_xor_b32 v41, s46, v41
    v_xor_b32 v43, s46, v43
    v_xor_b32 v45, s46, v45
    v_xor_b32 v47, s46, v47
    v_or3_b32 v31, v31, v41, v43
    v_or3_b32 v31, v31, v45, v47
    v_cmp_ne_u32 vcc, 0, v31
    s_nop 1
    s_cmp_eq_u64 vcc, 0
    s_cbranch_scc1 F_GAY_OK
    v_lshlrev_b32 v27, 4, v26
    buffer_load_dwordx4 a[0:3], v27, s[20:23], s47 offen offset:0 sc1
    buffer_load_dwordx4 a[4:7], v27, s[20:23], s47 offen offset:1024 sc1
    buffer_load_dwordx4 a[8:11], v27, s[20:23], s98 offen offset:0 sc1
    buffer_load_dwordx4 a[12:15], v27, s[20:23], s98 offen offset:1024 sc1
    s_waitcnt vmcnt(0)
    s_branch F_GAY
F_GAY_OK:
    v_add_f32 v32, v32, v34
    v_add_f32 v36, v36, v38
    v_add_f32 v32, v32, v36
    v_and_b32 v29, v22, v32
    v_sub_f32 v32, v32, v29
    v_and_b32 v35, v22, v32
    v_lshrrev_b32 v29, 16, v29
    v_or_b32 v34, v35, v29
    v_sub_f32 v32, v32, v35
    v_lshrrev_b32 v35, 16, v32
    s_add_u32 s53, s41, 4
    s_cmp_lt_u32 s41, 2
    s_cselect_b32 s52, s41, s53
    s_lshl_b32 s52, s52, 9
    s_add_u32 s52, s52, 158272
    v_lshl_add_u32 v27, v26, 3, s52
    ds_write_b64 v27, v[34:35]
    v_add_f32 v18, v40, v44
    v_add_f32 v36, v42, v46
    v_mov_b32 v37, v18
    s_nop 1
    v_permlane32_swap_b32 v18, v37
    v_add_f32 v18, v18, v37
    v_mov_b32 v19, v36
    s_nop 1
    v_permlane32_swap_b32 v36, v19
    v_add_f32 v36, v36, v19
    v_mul_f32 v18, 0x3b000000, v18
    v_mul_f32 v36, 0x3b000000, v36
    v_fma_f32 v36, -v18, v18, v36
    v_max_f32 v36, 0, v36
    v_cvt_pk_bf16_f32 v18, v18, v18
    v_and_b32 v18, s59, v18
    v_cvt_pk_bf16_f32 v36, v36, v36
    v_and_b32 v36, s59, v36
    v_add_f32 v36, 0x3727c5ac, v36
    v_cvt_pk_bf16_f32 v36, v36, v36
    v_and_b32 v36, s59, v36
    v_sqrt_f32 v36, v36
    s_nop 0
    v_cvt_pk_bf16_f32 v36, v36, v36
    v_and_b32 v36, s59, v36
    v_rcp_f32 v19, v36
    s_nop 0
    v_fma_f32 v37, -v36, v19, 1.0
    v_fmac_f32 v19, v37, v19
    v_and_b32 v28, 3, v26
    v_bfe_u32 v29, v26, 3, 2
    v_lshl_add_u32 v28, v29, 2, v28
    v_bfe_u32 v29, v26, 2, 1
    v_lshl_add_u32 v28, v29, 4, v28
    s_lshl_b32 s54, s41, 7
    s_add_u32 s54, s54, 147456
    v_lshl_add_u32 v27, v28, 2, s54
    ds_write_b32 v27, v19
    v_and_b32 v27, 31, v26
    s_lshl_b32 s54, s41, 8
    s_add_u32 s54, s54, 157248
    v_lshl_add_u32 v27, v27, 3, s54
    ds_write_b64 v27, v[18:19]
    v_lshlrev_b32 v28, 3, v28
    s_lshr_b32 s52, s48, 7
    s_add_u32 s52, s52, 10485760
    s_cmp_eq_u32 s43, 0
    s_cselect_b32 s52, s52, 1073741824
    buffer_store_dwordx2 v[18:19], v28, s[20:23], s52 offen sc1
    s_waitcnt lgkmcnt(0)
    s_barrier
    v_lshlrev_b32 v28, 3, v26
    v_add_u32 v28, 158272, v28
    ds_read_b64 v[36:37], v28 offset:3072
    ds_read_b64 v[40:41], v28 offset:3584
    v_lshrrev_b32 v29, 5, v26
    s_lshl_b32 s54, s41, 7
    s_add_u32 s54, s54, 147456
    v_lshl_add_u32 v28, v29, 6, s54
    ds_read_b128 v[48:51], v28 offset:0
    ds_read_b128 v[52:55], v28 offset:16
    ds_read_b128 v[56:59], v28 offset:32
    ds_read_b128 v[60:63], v28 offset:48
    v_and_b32 v27, 31, v26
    v_lshlrev_b32 v28, 5, v27
    v_add_u32 v28, 150016, v28
    ds_read_b128 v[2:5], v28
    ds_read_b64 v[12:13], v28 offset:16
    v_xor_b32 v33, 0x80000000, v18
    v_lshrrev_b32 v33, 16, v33
    v_lshl_or_b32 v32, v33, 16, v33
    v_mov_b32 v34, 0
    v_mov_b32 v35, 0
    v_mov_b32 v38, 0
    v_mov_b32 v39, 0
    v_mov_b32 v42, 0
    v_mov_b32 v43, 0
    s_waitcnt lgkmcnt(6)
    v_mfma_f32_32x32x16_bf16 v[64:79], v[32:35], v[36:39], v[64:79]
    v_mfma_f32_32x32x16_bf16 v[80:95], v[32:35], v[40:43], v[80:95]
    s_lshl_b32 s52, s41, 9
    s_add_u32 s52, s52, 147968
    v_lshl_add_u32 v28, v29, 8, s52
    v_lshl_add_u32 v28, v27, 3, v28
    s_lshl_b32 s52, s41, 1
    v_add_u32 v29, s52, v29
    s_lshl_b32 s52, s41, 2
    s_add_u32 s52, s52, 157184
    v_mov_b32 v30, s52
    v_mov_b32 v31, 1
    s_waitcnt lgkmcnt(0)
    v_mul_f32 v64, v64, v48
    v_mul_f32 v65, v65, v49
    v_mul_f32 v66, v66, v50
    v_mul_f32 v67, v67, v51
    v_mul_f32 v68, v68, v52
    v_mul_f32 v69, v69, v53
    v_mul_f32 v70, v70, v54
    v_mul_f32 v71, v71, v55
    v_mul_f32 v72, v72, v56
    v_mul_f32 v73, v73, v57
    v_mul_f32 v74, v74, v58
    v_mul_f32 v75, v75, v59
    v_mul_f32 v76, v76, v60
    v_mul_f32 v77, v77, v61
    v_mul_f32 v78, v78, v62
    v_mul_f32 v79, v79, v63
    v_mul_f32 v80, v80, v48
    v_mul_f32 v81, v81, v49
    v_mul_f32 v82, v82, v50
    v_mul_f32 v83, v83, v51
    v_mul_f32 v84, v84, v52
    v_mul_f32 v85, v85, v53
    v_mul_f32 v86, v86, v54
    v_mul_f32 v87, v87, v55
    v_mul_f32 v88, v88, v56
    v_mul_f32 v89, v89, v57
    v_mul_f32 v90, v90, v58
    v_mul_f32 v91, v91, v59
    v_mul_f32 v92, v92, v60
    v_mul_f32 v93, v93, v61
    v_mul_f32 v94, v94, v62
    v_mul_f32 v95, v95, v63
    v_fma_f32 v32, v2, v64, v65
    v_fma_f32 v33, v2, v80, v81
    v_fma_f32 v32, -v3, v80, v32
    v_fmac_f32 v33, v3, v64
    v_fma_f32 v34, v2, v32, v66
    v_fma_f32 v35, v2, v33, v82
    v_fma_f32 v34, -v3, v33, v34
    v_fmac_f32 v35, v3, v32
    v_fma_f32 v32, v2, v34, v67
    v_fma_f32 v33, v2, v35, v83
    v_fma_f32 v32, -v3, v35, v32
    v_fmac_f32 v33, v3, v34
    v_fma_f32 v34, v2, v32, v68
    v_fma_f32 v35, v2, v33, v84
    v_fma_f32 v34, -v3, v33, v34
    v_fmac_f32 v35, v3, v32
    v_fma_f32 v32, v2, v34, v69
    v_fma_f32 v33, v2, v35, v85
    v_fma_f32 v32, -v3, v35, v32
    v_fmac_f32 v33, v3, v34
    v_fma_f32 v34, v2, v32, v70
    v_fma_f32 v35, v2, v33, v86
    v_fma_f32 v34, -v3, v33, v34
    v_fmac_f32 v35, v3, v32
    v_fma_f32 v32, v2, v34, v71
    v_fma_f32 v33, v2, v35, v87
    v_fma_f32 v32, -v3, v35, v32
    v_fmac_f32 v33, v3, v34
    v_fma_f32 v34, v2, v32, v72
    v_fma_f32 v35, v2, v33, v88
    v_fma_f32 v34, -v3, v33, v34
    v_fmac_f32 v35, v3, v32
    v_fma_f32 v32, v2, v34, v73
    v_fma_f32 v33, v2, v35, v89
    v_fma_f32 v32, -v3, v35, v32
    v_fmac_f32 v33, v3, v34
    v_fma_f32 v34, v2, v32, v74
    v_fma_f32 v35, v2, v33, v90
    v_fma_f32 v34, -v3, v33, v34
    v_fmac_f32 v35, v3, v32
    v_fma_f32 v32, v2, v34, v75
    v_fma_f32 v33, v2, v35, v91
    v_fma_f32 v32, -v3, v35, v32
    v_fmac_f32 v33, v3, v34
    v_fma_f32 v34, v2, v32, v76
    v_fma_f32 v35, v2, v33, v92
    v_fma_f32 v34, -v3, v33, v34
    v_fmac_f32 v35, v3, v32
    v_fma_f32 v32, v2, v34, v77
    v_fma_f32 v33, v2, v35, v93
    v_fma_f32 v32, -v3, v35, v32
    v_fmac_f32 v33, v3, v34
    v_fma_f32 v34, v2, v32, v78
    v_fma_f32 v35, v2, v33, v94
    v_fma_f32 v34, -v3, v33, v34
    v_fmac_f32 v35, v3, v32
    v_fma_f32 v32, v2, v34, v79
    v_fma_f32 v33, v2, v35, v95
    v_fma_f32 v32, -v3, v35, v32
    v_fmac_f32 v33, v3, v34
    ds_write_b64 v28, v[32:33]
    ds_write_b32 v30, v31
    v_lshlrev_b32 v28, 3, v27
    v_add_u32 v28, 147968, v28
    v_mov_b32 v1, 0
    v_mov_b32 v8, 0
    v_mov_b32 v30, 157184
    s_waitcnt lgkmcnt(0)
F_YS1:
    ds_read_b128 v[36:39], v30
    ds_read_b64 v[48:49], v28 offset:0
    ds_read_b64 v[50:51], v28 offset:256
    ds_read_b64 v[52:53], v28 offset:512
    ds_read_b64 v[54:55], v28 offset:768
    ds_read_b64 v[56:57], v28 offset:1024
    ds_read_b64 v[58:59], v28 offset:1280
    ds_read_b64 v[60:61], v28 offset:1536
    ds_read_b64 v[62:63], v28 offset:1792
    s_waitcnt lgkmcnt(8)
    v_and_b32 v36, v36, v37
    v_and_b32 v38, v38, v39
    v_and_b32 v36, v36, v38
    s_nop 0
    v_readfirstlane_b32 s52, v36
    s_waitcnt lgkmcnt(0)
    s_cmp_eq_u32 s52, 1
    s_cbranch_scc0 F_YS1
    v_lshlrev_b32 v28, 4, v26
    v_mov_b32 v30, 1073741824
    v_cmp_gt_u32 vcc, 32, v26
    s_nop 1
    v_cndmask_b32 v28, v30, v28, vcc
    s_lshl_b32 s52, s43, 4
    s_add_u32 s52, s52, s42
    s_lshl_b32 s52, s52, 9
    s_add_u32 s52, s52, 11534336
    s_cmp_eq_u32 s41, 0
    s_cselect_b32 s52, s52, 1073741824
    v_mov_b32 v33, s46
    v_mov_b32 v35, s46
    v_fmac_f32 v50, v4, v48
    v_fmac_f32 v51, v4, v49
    v_fma_f32 v50, -v5, v49, v50
    v_fmac_f32 v51, v5, v48
    v_fmac_f32 v52, v4, v50
    v_fmac_f32 v53, v4, v51
    v_fma_f32 v52, -v5, v51, v52
    v_fmac_f32 v53, v5, v50
    v_fmac_f32 v54, v4, v52
    v_fmac_f32 v55, v4, v53
    v_fma_f32 v54, -v5, v53, v54
    v_fmac_f32 v55, v5, v52
    v_fmac_f32 v56, v4, v54
    v_fmac_f32 v57, v4, v55
    v_fma_f32 v56, -v5, v55, v56
    v_fmac_f32 v57, v5, v54
    v_fmac_f32 v58, v4, v56
    v_fmac_f32 v59, v4, v57
    v_fma_f32 v58, -v5, v57, v58
    v_fmac_f32 v59, v5, v56
    v_fmac_f32 v60, v4, v58
    v_fmac_f32 v61, v4, v59
    v_fma_f32 v60, -v5, v59, v60
    v_fmac_f32 v61, v5, v58
    v_fmac_f32 v62, v4, v60
    v_fmac_f32 v63, v4, v61
    v_fma_f32 v62, -v5, v61, v62
    v_fmac_f32 v63, v5, v60
    v_mov_b32 v32, v62
    v_mov_b32 v34, v63
    buffer_store_dwordx4 v[32:35], v28, s[20:23], s52 offen sc1
    v_cmp_eq_u32 vcc, 1, v29
    s_nop 1
    v_cndmask_b32 v1, v1, v48, vcc
    s_nop 0
    v_cndmask_b32 v8, v8, v49, vcc
    v_cmp_eq_u32 vcc, 2, v29
    s_nop 1
    v_cndmask_b32 v1, v1, v50, vcc
    s_nop 0
    v_cndmask_b32 v8, v8, v51, vcc
    v_cmp_eq_u32 vcc, 3, v29
    s_nop 1
    v_cndmask_b32 v1, v1, v52, vcc
    s_nop 0
    v_cndmask_b32 v8, v8, v53, vcc
    v_cmp_eq_u32 vcc, 4, v29
    s_nop 1
    v_cndmask_b32 v1, v1, v54, vcc
    s_nop 0
    v_cndmask_b32 v8, v8, v55, vcc
    v_cmp_eq_u32 vcc, 5, v29
    s_nop 1
    v_cndmask_b32 v1, v1, v56, vcc
    s_nop 0
    v_cndmask_b32 v8, v8, v57, vcc
    v_cmp_eq_u32 vcc, 6, v29
    s_nop 1
    v_cndmask_b32 v1, v1, v58, vcc
    s_nop 0
    v_cndmask_b32 v8, v8, v59, vcc
    v_cmp_eq_u32 vcc, 7, v29
    s_nop 1
    v_cndmask_b32 v1, v1, v60, vcc
    s_nop 0
    v_cndmask_b32 v8, v8, v61, vcc
    ds_read_b64_tr_b16 v[32:33], v9 offset:36864
    ds_read_b64_tr_b16 v[34:35], v9 offset:37632
    ds_read_b64_tr_b16 v[36:37], v9 offset:43008
    ds_read_b64_tr_b16 v[38:39], v9 offset:43776
    ds_read_b64_tr_b16 v[40:41], v9 offset:39936
    ds_read_b64_tr_b16 v[42:43], v9 offset:40704
    ds_read_b64_tr_b16 v[44:45], v9 offset:46080
    ds_read_b64_tr_b16 v[46:47], v9 offset:46848
    ds_read_b64_tr_b16 v[48:49], v9 offset:12288
    ds_read_b64_tr_b16 v[50:51], v9 offset:13056
    ds_read_b64_tr_b16 v[52:53], v9 offset:18432
    ds_read_b64_tr_b16 v[54:55], v9 offset:19200
    ds_read_b64_tr_b16 v[56:57], v9 offset:15360
    ds_read_b64_tr_b16 v[58:59], v9 offset:16128
    ds_read_b64_tr_b16 v[60:61], v9 offset:21504
    ds_read_b64_tr_b16 v[62:63], v9 offset:22272
    s_waitcnt lgkmcnt(12)
    v_mfma_f32_32x32x16_bf16 v[96:111], v[32:35], a[16:19], v[96:111]
    v_mfma_f32_32x32x16_bf16 v[112:127], v[36:39], a[16:19], v[112:127]
    ds_read_b64_tr_b16 v[32:33], v9 offset:24576
    ds_read_b64_tr_b16 v[34:35], v9 offset:25344
    ds_read_b64_tr_b16 v[36:37], v9 offset:30720
    ds_read_b64_tr_b16 v[38:39], v9 offset:31488
    s_waitcnt lgkmcnt(12)
    v_mfma_f32_32x32x16_bf16 v[96:111], v[40:43], a[20:23], v[96:111]
    v_mfma_f32_32x32x16_bf16 v[112:127], v[44:47], a[20:23], v[112:127]
    ds_read_b64_tr_b16 v[40:41], v9 offset:27648
    ds_read_b64_tr_b16 v[42:43], v9 offset:28416
    ds_read_b64_tr_b16 v[44:45], v9 offset:33792
    ds_read_b64_tr_b16 v[46:47], v9 offset:34560
    s_lshl_b32 s52, s85, 5
    s_lshl_b32 s53, s41, 3
    s_add_u32 s52, s52, s53
    s_add_u32 s52, s52, 344
    s_lshl_b32 s87, s84, 17
    s_lshl_b32 s53, s41, 14
    s_add_u32 s87, s87, s53
    s_add_u32 s87, s87, 6291456
    s_lshl_b32 s86, s52, 12
    s_add_u32 s86, s86, 13631488
    s_lshl_b32 s99, s52, 2
    s_add_u32 s99, s99, 10616832
    v_lshlrev_b32 v11, 4, v26
    s_mov_b32 s52, 8
    v_lshlrev_b32 v14, 2, v26
    v_cmp_gt_u32 vcc, s52, v26
    s_nop 1
    v_cndmask_b32 v14, 0, v14, vcc
    buffer_load_dword v15, v14, s[20:23], s99 offen sc1
    s_waitcnt lgkmcnt(12)
    v_mfma_f32_32x32x16_bf16 v[96:111], v[48:51], a[24:27], v[96:111]
    v_mfma_f32_32x32x16_bf16 v[112:127], v[52:55], a[24:27], v[112:127]
    ds_read_b64_tr_b16 v[48:49], v9 offset:49152
    ds_read_b64_tr_b16 v[50:51], v9 offset:49920
    ds_read_b64_tr_b16 v[52:53], v9 offset:55296
    ds_read_b64_tr_b16 v[54:55], v9 offset:56064
    s_waitcnt lgkmcnt(12)
    v_mfma_f32_32x32x16_bf16 v[96:111], v[56:59], a[28:31], v[96:111]
    v_mfma_f32_32x32x16_bf16 v[112:127], v[60:63], a[28:31], v[112:127]
    ds_read_b64_tr_b16 v[56:57], v9 offset:52224
    ds_read_b64_tr_b16 v[58:59], v9 offset:52992
    ds_read_b64_tr_b16 v[60:61], v9 offset:58368
    ds_read_b64_tr_b16 v[62:63], v9 offset:59136
    s_waitcnt lgkmcnt(12)
    v_mfma_f32_32x32x16_bf16 v[96:111], v[32:35], a[32:35], v[96:111]
    v_mfma_f32_32x32x16_bf16 v[112:127], v[36:39], a[32:35], v[112:127]
    ds_read_b64_tr_b16 v[32:33], v10 offset:0
    ds_read_b64_tr_b16 v[34:35], v10 offset:768
    ds_read_b64_tr_b16 v[36:37], v10 offset:6144
    ds_read_b64_tr_b16 v[38:39], v10 offset:6912
    s_waitcnt lgkmcnt(12)
    v_mfma_f32_32x32x16_bf16 v[96:111], v[40:43], a[36:39], v[96:111]
    v_mfma_f32_32x32x16_bf16 v[112:127], v[44:47], a[36:39], v[112:127]
    ds_read_b64_tr_b16 v[40:41], v10 offset:3072
    ds_read_b64_tr_b16 v[42:43], v10 offset:3840
    ds_read_b64_tr_b16 v[44:45], v10 offset:9216
    ds_read_b64_tr_b16 v[46:47], v10 offset:9984
    s_waitcnt vmcnt(0)
F_RFY:
    v_xor_b32 v31, s46, v15
    v_cmp_ne_u32 vcc, 0, v31
    s_nop 1
    s_cmp_eq_u64 vcc, 0
    s_cbranch_scc1 F_RFY_OK
    buffer_load_dword v15, v14, s[20:23], s99 offen sc1
    s_waitcnt vmcnt(0)
    s_branch F_RFY
F_RFY_OK:
    s_add_u32 s52, s86, 0
    buffer_load_dwordx4 a[16:19], v11, s[20:23], s52 offen offset:0 sc1
    s_add_u32 s52, s86, 0
    buffer_load_dwordx4 a[20:23], v11, s[20:23], s52 offen offset:1024 sc1
    s_waitcnt lgkmcnt(12)
    v_mfma_f32_32x32x16_bf16 v[96:111], v[48:51], a[40:43], v[96:111]
    v_mfma_f32_32x32x16_bf16 v[112:127], v[52:55], a[40:43], v[112:127]
    s_add_u32 s52, s86, 0
    buffer_load_dwordx4 a[24:27], v11, s[20:23], s52 offen offset:2048 sc1
    s_add_u32 s52, s86, 0
    buffer_load_dwordx4 a[28:31], v11, s[20:23], s52 offen offset:3072 sc1
    s_waitcnt lgkmcnt(8)
    v_mfma_f32_32x32x16_bf16 v[96:111], v[56:59], a[44:47], v[96:111]
    v_mfma_f32_32x32x16_bf16 v[112:127], v[60:63], a[44:47], v[112:127]
    s_waitcnt lgkmcnt(0)
    s_barrier
    ds_read_b64_tr_b16 v[48:49], v10 offset:12288
    ds_read_b64_tr_b16 v[50:51], v10 offset:13056
    ds_read_b64_tr_b16 v[52:53], v10 offset:18432
    ds_read_b64_tr_b16 v[54:55], v10 offset:19200
    ds_read_b64_tr_b16 v[56:57], v10 offset:15360
    ds_read_b64_tr_b16 v[58:59], v10 offset:16128
    ds_read_b64_tr_b16 v[60:61], v10 offset:21504
    ds_read_b64_tr_b16 v[62:63], v10 offset:22272
    s_add_u32 s52, s86, 4096
    buffer_load_dwordx4 a[32:35], v11, s[20:23], s52 offen offset:0 sc1
    s_add_u32 s52, s86, 4096
    buffer_load_dwordx4 a[36:39], v11, s[20:23], s52 offen offset:1024 sc1
    v_mfma_f32_32x32x16_bf16 v[96:111], v[32:35], a[48:51], v[96:111]
    v_mfma_f32_32x32x16_bf16 v[112:127], v[36:39], a[48:51], v[112:127]
    ds_read_b64_tr_b16 v[32:33], v10 offset:24576
    ds_read_b64_tr_b16 v[34:35], v10 offset:25344
    ds_read_b64_tr_b16 v[36:37], v10 offset:30720
    ds_read_b64_tr_b16 v[38:39], v10 offset:31488
    s_add_u32 s52, s86, 4096
    buffer_load_dwordx4 a[40:43], v11, s[20:23], s52 offen offset:2048 sc1
    s_add_u32 s52, s86, 4096
    buffer_load_dwordx4 a[44:47], v11, s[20:23], s52 offen offset:3072 sc1
    v_mfma_f32_32x32x16_bf16 v[96:111], v[40:43], a[52:55], v[96:111]
    v_mfma_f32_32x32x16_bf16 v[112:127], v[44:47], a[52:55], v[112:127]
    ds_read_b64_tr_b16 v[40:41], v10 offset:27648
    ds_read_b64_tr_b16 v[42:43], v10 offset:28416
    ds_read_b64_tr_b16 v[44:45], v10 offset:33792
    ds_read_b64_tr_b16 v[46:47], v10 offset:34560
    s_waitcnt lgkmcnt(12)
    v_mfma_f32_32x32x16_bf16 v[96:111], v[48:51], a[56:59], v[96:111]
    v_mfma_f32_32x32x16_bf16 v[112:127], v[52:55], a[56:59], v[112:127]
    ds_read_b64_tr_b16 v[48:49], v10 offset:36864
    ds_read_b64_tr_b16 v[50:51], v10 offset:37632
    ds_read_b64_tr_b16 v[52:53], v10 offset:43008
    ds_read_b64_tr_b16 v[54:55], v10 offset:43776
    s_waitcnt lgkmcnt(12)
    v_mfma_f32_32x32x16_bf16 v[96:111], v[56:59], a[60:63], v[96:111]
    v_mfma_f32_32x32x16_bf16 v[112:127], v[60:63], a[60:63], v[112:127]
    ds_read_b64_tr_b16 v[56:57], v10 offset:39936
    ds_read_b64_tr_b16 v[58:59], v10 offset:40704
    ds_read_b64_tr_b16 v[60:61], v10 offset:46080
    ds_read_b64_tr_b16 v[62:63], v10 offset:46848
    v_lshlrev_b32 v27, 4, v26
    s_lshl_b32 s52, s43, 13
    s_lshl_b32 s53, s41, 10
    s_add_u32 s52, s52, s53
    s_add_u32 s52, s52, 11534336
    s_add_u32 s53, s52, 4096
    buffer_load_dwordx4 a[8:11], v27, s[20:23], s52 offen sc1
    buffer_load_dwordx4 a[12:15], v27, s[20:23], s53 offen sc1
    s_add_u32 s52, s86, 8192
    buffer_load_dwordx4 a[48:51], v11, s[20:23], s52 offen offset:0 sc1
    s_add_u32 s52, s86, 8192
    buffer_load_dwordx4 a[52:55], v11, s[20:23], s52 offen offset:1024 sc1
    s_waitcnt lgkmcnt(12)
    v_mfma_f32_32x32x16_bf16 v[96:111], v[32:35], a[64:67], v[96:111]
    v_mfma_f32_32x32x16_bf16 v[112:127], v[36:39], a[64:67], v[112:127]
    s_add_u32 s52, s86, 8192
    buffer_load_dwordx4 a[56:59], v11, s[20:23], s52 offen offset:2048 sc1
    s_add_u32 s52, s86, 8192
    buffer_load_dwordx4 a[60:63], v11, s[20:23], s52 offen offset:3072 sc1
    s_waitcnt lgkmcnt(8)
    v_mfma_f32_32x32x16_bf16 v[96:111], v[40:43], a[68:71], v[96:111]
    v_mfma_f32_32x32x16_bf16 v[112:127], v[44:47], a[68:71], v[112:127]
    s_waitcnt lgkmcnt(4)
    v_mfma_f32_32x32x16_bf16 v[96:111], v[48:51], a[72:75], v[96:111]
    v_mfma_f32_32x32x16_bf16 v[112:127], v[52:55], a[72:75], v[112:127]
    s_waitcnt lgkmcnt(0)
    v_mfma_f32_32x32x16_bf16 v[96:111], v[56:59], a[76:79], v[96:111]
    v_mfma_f32_32x32x16_bf16 v[112:127], v[60:63], a[76:79], v[112:127]
    v_and_b32 v27, 31, v26
    v_lshrrev_b32 v29, 5, v26
    s_lshl_b32 s54, s41, 1
    v_add_u32 v29, s54, v29
    v_lshl_add_u32 v30, v29, 5, v27
    v_mul_u32_u24 v28, 24, v30
    v_add_u32 v28, 151040, v28
    ds_read_b64 v[40:41], v28 offset:0
    ds_read_b64 v[42:43], v28 offset:8
    ds_read_b64 v[44:45], v28 offset:16
    v_lshlrev_b32 v20, 3, v30
    v_add_u32 v20, 147968, v20
    s_sub_u32 s55, s42, 8
    s_waitcnt vmcnt(4)
F_POLL:
    v_accvgpr_read_b32 v32, a8
    v_accvgpr_read_b32 v33, a9
    v_accvgpr_read_b32 v34, a10
    v_accvgpr_read_b32 v35, a11
    v_accvgpr_read_b32 v36, a12
    v_accvgpr_read_b32 v37, a13
    v_accvgpr_read_b32 v38, a14
    v_accvgpr_read_b32 v39, a15
    v_xor_b32 v33, s46, v33
    v_xor_b32 v35, s46, v35
    v_xor_b32 v37, s46, v37
    v_xor_b32 v39, s46, v39
    v_or_b32 v33, v33, v35
    v_or_b32 v37, v37, v39
    v_cmp_gt_i32 vcc, s42, v29
    s_nop 1
    v_cndmask_b32 v32, 0, v32, vcc
    s_nop 0
    v_cndmask_b32 v33, 0, v33, vcc
    v_cndmask_b32 v34, 0, v34, vcc
    v_cmp_gt_i32 vcc, s55, v29
    s_nop 1
    v_cndmask_b32 v36, 0, v36, vcc
    s_nop 0
    v_cndmask_b32 v37, 0, v37, vcc
    v_cndmask_b32 v38, 0, v38, vcc
    v_or_b32 v31, v33, v37
    v_cmp_ne_u32 vcc, 0, v31
    s_nop 1
    s_cmp_eq_u64 vcc, 0
    s_cbranch_scc1 F_POLL_OK
    v_lshlrev_b32 v27, 4, v26
    s_lshl_b32 s52, s43, 13
    s_lshl_b32 s53, s41, 10
    s_add_u32 s52, s52, s53
    s_add_u32 s52, s52, 11534336
    s_add_u32 s53, s52, 4096
    buffer_load_dwordx4 a[8:11], v27, s[20:23], s52 offen sc1
    buffer_load_dwordx4 a[12:15], v27, s[20:23], s53 offen sc1
    s_waitcnt vmcnt(0)
    s_branch F_POLL
F_POLL_OK:
    s_waitcnt lgkmcnt(0)
    v_mul_f32 v46, v42, v32
    v_mul_f32 v47, v42, v34
    v_fma_f32 v46, -v43, v34, v46
    v_fmac_f32 v47, v43, v32
    v_fmac_f32 v46, v44, v36
    v_fmac_f32 v47, v44, v38
    v_fma_f32 v46, -v45, v38, v46
    v_fmac_f32 v47, v45, v36
    s_lshl_b32 s52, s41, 2
    s_add_u32 s52, s52, 157200
    v_mov_b32 v30, s52
    v_mov_b32 v31, 1
    ds_write_b64 v20, v[46:47]
    ds_write_b32 v30, v31
    v_and_b32 v27, 31, v26
    v_lshlrev_b32 v28, 3, v27
    v_add_u32 v28, 147968, v28
    v_mov_b32 v30, 157200
    s_waitcnt lgkmcnt(0)
F_YS2:
    ds_read_b128 v[32:35], v30
    ds_read_b64 v[48:49], v28 offset:0
    ds_read_b64 v[50:51], v28 offset:256
    ds_read_b64 v[52:53], v28 offset:512
    ds_read_b64 v[54:55], v28 offset:768
    ds_read_b64 v[56:57], v28 offset:1024
    ds_read_b64 v[58:59], v28 offset:1280
    ds_read_b64 v[60:61], v28 offset:1536
    ds_read_b64 v[62:63], v28 offset:1792
    s_waitcnt lgkmcnt(8)
    v_and_b32 v32, v32, v33
    v_and_b32 v34, v34, v35
    v_and_b32 v32, v32, v34
    s_nop 0
    v_readfirstlane_b32 s52, v32
    s_waitcnt lgkmcnt(0)
    s_cmp_eq_u32 s52, 1
    s_cbranch_scc0 F_YS2
    v_add_f32 v48, v48, v56
    v_add_f32 v49, v49, v57
    v_add_f32 v50, v50, v58
    v_add_f32 v51, v51, v59
    v_add_f32 v52, v52, v60
    v_add_f32 v53, v53, v61
    v_add_f32 v54, v54, v62
    v_add_f32 v55, v55, v63
    v_add_f32 v48, v48, v52
    v_add_f32 v49, v49, v53
    v_add_f32 v50, v50, v54
    v_add_f32 v51, v51, v55
    v_add_f32 v48, v48, v50
    v_add_f32 v49, v49, v51
    v_fmac_f32 v1, v40, v48
    v_fmac_f32 v8, v40, v49
    v_fma_f32 v1, -v41, v49, v1
    v_fmac_f32 v8, v41, v48
    v_lshrrev_b32 v30, 5, v26
    v_mul_u32_u24 v30, 1280, v30
    s_mul_i32 s54, s41, 5120
    s_add_u32 s54, s54, 65536
    v_lshl_add_u32 v30, v27, 1, v30
    v_add_u32 v30, s54, v30
    v_fmac_f32 v64, v2, v1
    v_fmac_f32 v80, v2, v8
    v_fma_f32 v64, -v3, v8, v64
    v_fmac_f32 v80, v3, v1
    v_mul_f32 v32, v12, v64
    v_mul_f32 v33, v12, v80
    v_fma_f32 v32, -v13, v80, v32
    v_fmac_f32 v33, v13, v64
    v_cvt_pk_bf16_f32 v40, v32, -v33
    ds_write_b16 v30, v40 offset:0
    ds_write_b16_d16_hi v30, v40 offset:2560
    v_fmac_f32 v65, v2, v64
    v_fmac_f32 v81, v2, v80
    v_fma_f32 v65, -v3, v80, v65
    v_fmac_f32 v81, v3, v64
    v_mul_f32 v34, v12, v65
    v_mul_f32 v35, v12, v81
    v_fma_f32 v34, -v13, v81, v34
    v_fmac_f32 v35, v13, v65
    v_cvt_pk_bf16_f32 v41, v34, -v35
    ds_write_b16 v30, v41 offset:80
    ds_write_b16_d16_hi v30, v41 offset:2640
    v_fmac_f32 v66, v2, v65
    v_fmac_f32 v82, v2, v81
    v_fma_f32 v66, -v3, v81, v66
    v_fmac_f32 v82, v3, v65
    v_mul_f32 v36, v12, v66
    v_mul_f32 v37, v12, v82
    v_fma_f32 v36, -v13, v82, v36
    v_fmac_f32 v37, v13, v66
    v_cvt_pk_bf16_f32 v42, v36, -v37
    ds_write_b16 v30, v42 offset:160
    ds_write_b16_d16_hi v30, v42 offset:2720
    v_fmac_f32 v67, v2, v66
    v_fmac_f32 v83, v2, v82
    v_fma_f32 v67, -v3, v82, v67
    v_fmac_f32 v83, v3, v66
    v_mul_f32 v38, v12, v67
    v_mul_f32 v39, v12, v83
    v_fma_f32 v38, -v13, v83, v38
    v_fmac_f32 v39, v13, v67
    v_cvt_pk_bf16_f32 v43, v38, -v39
    ds_write_b16 v30, v43 offset:240
    ds_write_b16_d16_hi v30, v43 offset:2800
    v_fmac_f32 v68, v2, v67
    v_fmac_f32 v84, v2, v83
    v_fma_f32 v68, -v3, v83, v68
    v_fmac_f32 v84, v3, v67
    v_mul_f32 v32, v12, v68
    v_mul_f32 v33, v12, v84
    v_fma_f32 v32, -v13, v84, v32
    v_fmac_f32 v33, v13, v68
    v_cvt_pk_bf16_f32 v44, v32, -v33
    ds_write_b16 v30, v44 offset:320
    ds_write_b16_d16_hi v30, v44 offset:2880
    v_fmac_f32 v69, v2, v68
    v_fmac_f32 v85, v2, v84
    v_fma_f32 v69, -v3, v84, v69
    v_fmac_f32 v85, v3, v68
    v_mul_f32 v34, v12, v69
    v_mul_f32 v35, v12, v85
    v_fma_f32 v34, -v13, v85, v34
    v_fmac_f32 v35, v13, v69
    v_cvt_pk_bf16_f32 v45, v34, -v35
    ds_write_b16 v30, v45 offset:400
    ds_write_b16_d16_hi v30, v45 offset:2960
    v_fmac_f32 v70, v2, v69
    v_fmac_f32 v86, v2, v85
    v_fma_f32 v70, -v3, v85, v70
    v_fmac_f32 v86, v3, v69
    v_mul_f32 v36, v12, v70
    v_mul_f32 v37, v12, v86
    v_fma_f32 v36, -v13, v86, v36
    v_fmac_f32 v37, v13, v70
    v_cvt_pk_bf16_f32 v46, v36, -v37
    ds_write_b16 v30, v46 offset:480
    ds_write_b16_d16_hi v30, v46 offset:3040
    v_fmac_f32 v71, v2, v70
    v_fmac_f32 v87, v2, v86
    v_fma_f32 v71, -v3, v86, v71
    v_fmac_f32 v87, v3, v70
    v_mul_f32 v38, v12, v71
    v_mul_f32 v39, v12, v87
    v_fma_f32 v38, -v13, v87, v38
    v_fmac_f32 v39, v13, v71
    v_cvt_pk_bf16_f32 v47, v38, -v39
    ds_write_b16 v30, v47 offset:560
    ds_write_b16_d16_hi v30, v47 offset:3120
    v_fmac_f32 v72, v2, v71
    v_fmac_f32 v88, v2, v87
    v_fma_f32 v72, -v3, v87, v72
    v_fmac_f32 v88, v3, v71
    v_mul_f32 v32, v12, v72
    v_mul_f32 v33, v12, v88
    v_fma_f32 v32, -v13, v88, v32
    v_fmac_f32 v33, v13, v72
    v_cvt_pk_bf16_f32 v48, v32, -v33
    ds_write_b16 v30, v48 offset:640
    ds_write_b16_d16_hi v30, v48 offset:3200
    v_fmac_f32 v73, v2, v72
    v_fmac_f32 v89, v2, v88
    v_fma_f32 v73, -v3, v88, v73
    v_fmac_f32 v89, v3, v72
    v_mul_f32 v34, v12, v73
    v_mul_f32 v35, v12, v89
    v_fma_f32 v34, -v13, v89, v34
    v_fmac_f32 v35, v13, v73
    v_cvt_pk_bf16_f32 v49, v34, -v35
    ds_write_b16 v30, v49 offset:720
    ds_write_b16_d16_hi v30, v49 offset:3280
    v_fmac_f32 v74, v2, v73
    v_fmac_f32 v90, v2, v89
    v_fma_f32 v74, -v3, v89, v74
    v_fmac_f32 v90, v3, v73
    v_mul_f32 v36, v12, v74
    v_mul_f32 v37, v12, v90
    v_fma_f32 v36, -v13, v90, v36
    v_fmac_f32 v37, v13, v74
    v_cvt_pk_bf16_f32 v50, v36, -v37
    ds_write_b16 v30, v50 offset:800
    ds_write_b16_d16_hi v30, v50 offset:3360
    v_fmac_f32 v75, v2, v74
    v_fmac_f32 v91, v2, v90
    v_fma_f32 v75, -v3, v90, v75
    v_fmac_f32 v91, v3, v74
    v_mul_f32 v38, v12, v75
    v_mul_f32 v39, v12, v91
    v_fma_f32 v38, -v13, v91, v38
    v_fmac_f32 v39, v13, v75
    v_cvt_pk_bf16_f32 v51, v38, -v39
    ds_write_b16 v30, v51 offset:880
    ds_write_b16_d16_hi v30, v51 offset:3440
    v_fmac_f32 v76, v2, v75
    v_fmac_f32 v92, v2, v91
    v_fma_f32 v76, -v3, v91, v76
    v_fmac_f32 v92, v3, v75
    v_mul_f32 v32, v12, v76
    v_mul_f32 v33, v12, v92
    v_fma_f32 v32, -v13, v92, v32
    v_fmac_f32 v33, v13, v76
    v_cvt_pk_bf16_f32 v52, v32, -v33
    ds_write_b16 v30, v52 offset:960
    ds_write_b16_d16_hi v30, v52 offset:3520
    v_fmac_f32 v77, v2, v76
    v_fmac_f32 v93, v2, v92
    v_fma_f32 v77, -v3, v92, v77
    v_fmac_f32 v93, v3, v76
    v_mul_f32 v34, v12, v77
    v_mul_f32 v35, v12, v93
    v_fma_f32 v34, -v13, v93, v34
    v_fmac_f32 v35, v13, v77
    v_cvt_pk_bf16_f32 v53, v34, -v35
    ds_write_b16 v30, v53 offset:1040
    ds_write_b16_d16_hi v30, v53 offset:3600
    v_fmac_f32 v78, v2, v77
    v_fmac_f32 v94, v2, v93
    v_fma_f32 v78, -v3, v93, v78
    v_fmac_f32 v94, v3, v77
    v_mul_f32 v36, v12, v78
    v_mul_f32 v37, v12, v94
    v_fma_f32 v36, -v13, v94, v36
    v_fmac_f32 v37, v13, v78
    v_cvt_pk_bf16_f32 v54, v36, -v37
    ds_write_b16 v30, v54 offset:1120
    ds_write_b16_d16_hi v30, v54 offset:3680
    v_fmac_f32 v79, v2, v78
    v_fmac_f32 v95, v2, v94
    v_fma_f32 v79, -v3, v94, v79
    v_fmac_f32 v95, v3, v78
    v_mul_f32 v38, v12, v79
    v_mul_f32 v39, v12, v95
    v_fma_f32 v38, -v13, v95, v38
    v_fmac_f32 v39, v13, v79
    v_cvt_pk_bf16_f32 v55, v38, -v39
    ds_write_b16 v30, v55 offset:1200
    ds_write_b16_d16_hi v30, v55 offset:3760
    v_and_b32 v27, 3, v26
    v_bfe_u32 v29, v26, 3, 2
    v_lshl_add_u32 v27, v29, 2, v27
    v_bfe_u32 v29, v26, 2, 1
    v_lshl_add_u32 v27, v29, 4, v27
    v_mul_u32_u24 v27, 80, v27
    v_lshrrev_b32 v29, 5, v26
    v_lshl_add_u32 v27, v29, 4, v27
    v_add_u32 v27, s54, v27
    v_lshlrev_b32 v28, 4, v26
    s_lshl_b32 s52, s42, 2
    s_add_u32 s52, s52, s41
    s_lshl_b32 s52, s52, 16
    s_lshl_b32 s53, s43, 11
    s_add_u32 s52, s52, s53
    s_add_u32 s52, s52, 6291456
    s_add_u32 s53, s52, 32768
    ds_read_b128 v[64:67], v27 offset:0
    ds_read_b128 v[68:71], v27 offset:32
    ds_read_b128 v[72:75], v27 offset:2560
    ds_read_b128 v[76:79], v27 offset:2592
    s_waitcnt lgkmcnt(0)
    buffer_store_dwordx4 v[64:67], v28, s[20:23], s52 offen offset:0 sc1
    buffer_store_dwordx4 v[68:71], v28, s[20:23], s52 offen offset:1024 sc1
    buffer_store_dwordx4 v[72:75], v28, s[20:23], s53 offen offset:0 sc1
    buffer_store_dwordx4 v[76:79], v28, s[20:23], s53 offen offset:1024 sc1
    ds_read_b64_tr_b16 v[32:33], v9 offset:0
    ds_read_b64_tr_b16 v[34:35], v9 offset:768
    ds_read_b64_tr_b16 v[36:37], v9 offset:6144
    ds_read_b64_tr_b16 v[38:39], v9 offset:6912
    ds_read_b64_tr_b16 v[40:41], v9 offset:3072
    ds_read_b64_tr_b16 v[42:43], v9 offset:3840
    ds_read_b64_tr_b16 v[44:45], v9 offset:9216
    ds_read_b64_tr_b16 v[46:47], v9 offset:9984
    ds_read_b64_tr_b16 v[48:49], v10 offset:49152
    ds_read_b64_tr_b16 v[50:51], v10 offset:49920
    ds_read_b64_tr_b16 v[52:53], v10 offset:55296
    ds_read_b64_tr_b16 v[54:55], v10 offset:56064
    ds_read_b64_tr_b16 v[56:57], v10 offset:52224
    ds_read_b64_tr_b16 v[58:59], v10 offset:52992
    ds_read_b64_tr_b16 v[60:61], v10 offset:58368
    ds_read_b64_tr_b16 v[62:63], v10 offset:59136
    s_add_u32 s52, s86, 12288
    buffer_load_dwordx4 a[64:67], v11, s[20:23], s52 offen offset:0 sc1
    s_add_u32 s52, s86, 12288
    buffer_load_dwordx4 a[68:71], v11, s[20:23], s52 offen offset:1024 sc1
    s_waitcnt lgkmcnt(12)
    v_mfma_f32_32x32x16_bf16 v[96:111], v[32:35], a[80:83], v[96:111]
    v_mfma_f32_32x32x16_bf16 v[112:127], v[36:39], a[80:83], v[112:127]
    s_add_u32 s52, s86, 12288
    buffer_load_dwordx4 a[72:75], v11, s[20:23], s52 offen offset:2048 sc1
    s_add_u32 s52, s86, 12288
    buffer_load_dwordx4 a[76:79], v11, s[20:23], s52 offen offset:3072 sc1
    s_waitcnt lgkmcnt(8)
    v_mfma_f32_32x32x16_bf16 v[96:111], v[40:43], a[84:87], v[96:111]
    v_mfma_f32_32x32x16_bf16 v[112:127], v[44:47], a[84:87], v[112:127]
    s_waitcnt lgkmcnt(0)
    s_barrier
    ds_read_b64_tr_b16 v[32:33], v9 offset:12288
    ds_read_b64_tr_b16 v[34:35], v9 offset:13056
    ds_read_b64_tr_b16 v[36:37], v9 offset:18432
    ds_read_b64_tr_b16 v[38:39], v9 offset:19200
    ds_read_b64_tr_b16 v[40:41], v9 offset:15360
    ds_read_b64_tr_b16 v[42:43], v9 offset:16128
    ds_read_b64_tr_b16 v[44:45], v9 offset:21504
    ds_read_b64_tr_b16 v[46:47], v9 offset:22272
    v_mfma_f32_32x32x16_bf16 v[96:111], v[48:51], a[88:91], v[96:111]
    v_mfma_f32_32x32x16_bf16 v[112:127], v[52:55], a[88:91], v[112:127]
    ds_read_b64_tr_b16 v[48:49], v9 offset:24576
    ds_read_b64_tr_b16 v[50:51], v9 offset:25344
    ds_read_b64_tr_b16 v[52:53], v9 offset:30720
    ds_read_b64_tr_b16 v[54:55], v9 offset:31488
    v_mfma_f32_32x32x16_bf16 v[96:111], v[56:59], a[92:95], v[96:111]
    v_mfma_f32_32x32x16_bf16 v[112:127], v[60:63], a[92:95], v[112:127]
    ds_read_b64_tr_b16 v[56:57], v9 offset:27648
    ds_read_b64_tr_b16 v[58:59], v9 offset:28416
    ds_read_b64_tr_b16 v[60:61], v9 offset:33792
    ds_read_b64_tr_b16 v[62:63], v9 offset:34560
    s_add_u32 s52, s86, 16384
    buffer_load_dwordx4 a[80:83], v11, s[20:23], s52 offen offset:0 sc1
    s_add_u32 s52, s86, 16384
    buffer_load_dwordx4 a[84:87], v11, s[20:23], s52 offen offset:1024 sc1
    s_waitcnt lgkmcnt(12)
    v_mfma_f32_32x32x16_bf16 v[96:111], v[32:35], a[96:99], v[96:111]
    v_mfma_f32_32x32x16_bf16 v[112:127], v[36:39], a[96:99], v[112:127]
    ds_read_b64_tr_b16 v[32:33], v9 offset:36864
    ds_read_b64_tr_b16 v[34:35], v9 offset:37632
    ds_read_b64_tr_b16 v[36:37], v9 offset:43008
    ds_read_b64_tr_b16 v[38:39], v9 offset:43776
    s_add_u32 s52, s86, 16384
    buffer_load_dwordx4 a[88:91], v11, s[20:23], s52 offen offset:2048 sc1
    s_add_u32 s52, s86, 16384
    buffer_load_dwordx4 a[92:95], v11, s[20:23], s52 offen offset:3072 sc1
    s_waitcnt lgkmcnt(12)
    v_mfma_f32_32x32x16_bf16 v[96:111], v[40:43], a[100:103], v[96:111]
    v_mfma_f32_32x32x16_bf16 v[112:127], v[44:47], a[100:103], v[112:127]
    ds_read_b64_tr_b16 v[40:41], v9 offset:39936
    ds_read_b64_tr_b16 v[42:43], v9 offset:40704
    ds_read_b64_tr_b16 v[44:45], v9 offset:46080
    ds_read_b64_tr_b16 v[46:47], v9 offset:46848
    s_waitcnt lgkmcnt(12)
    v_mfma_f32_32x32x16_bf16 v[96:111], v[48:51], a[104:107], v[96:111]
    v_mfma_f32_32x32x16_bf16 v[112:127], v[52:55], a[104:107], v[112:127]
    ds_read_b64_tr_b16 v[48:49], v9 offset:49152
    ds_read_b64_tr_b16 v[50:51], v9 offset:49920
    ds_read_b64_tr_b16 v[52:53], v9 offset:55296
    ds_read_b64_tr_b16 v[54:55], v9 offset:56064
    s_waitcnt lgkmcnt(12)
    v_mfma_f32_32x32x16_bf16 v[96:111], v[56:59], a[108:111], v[96:111]
    v_mfma_f32_32x32x16_bf16 v[112:127], v[60:63], a[108:111], v[112:127]
    ds_read_b64_tr_b16 v[56:57], v9 offset:52224
    ds_read_b64_tr_b16 v[58:59], v9 offset:52992
    ds_read_b64_tr_b16 v[60:61], v9 offset:58368
    ds_read_b64_tr_b16 v[62:63], v9 offset:59136
    s_waitcnt vmcnt(8)
    s_lshl_b32 s52, s42, 2
    s_add_u32 s52, s52, s41
    s_lshl_b32 s52, s52, 8
    s_lshl_b32 s53, s43, 2
    s_add_u32 s52, s52, s53
    s_add_u32 s52, s52, 10551424
    v_mov_b32 v30, 1073741824
    v_cmp_eq_u32 vcc, 0, v26
    v_mov_b32 v31, s46
    s_nop 0
    v_cndmask_b32 v30, v30, 0, vcc
    buffer_store_dword v31, v30, s[20:23], s52 offen sc1
    s_add_u32 s52, s86, 20480
    buffer_load_dwordx4 a[96:99], v11, s[20:23], s52 offen offset:0 sc1
    s_add_u32 s52, s86, 20480
    buffer_load_dwordx4 a[100:103], v11, s[20:23], s52 offen offset:1024 sc1
    s_waitcnt lgkmcnt(12)
    v_mfma_f32_32x32x16_bf16 v[96:111], v[32:35], a[112:115], v[96:111]
    v_mfma_f32_32x32x16_bf16 v[112:127], v[36:39], a[112:115], v[112:127]
    s_add_u32 s52, s86, 20480
    buffer_load_dwordx4 a[104:107], v11, s[20:23], s52 offen offset:2048 sc1
    s_add_u32 s52, s86, 20480
    buffer_load_dwordx4 a[108:111], v11, s[20:23], s52 offen offset:3072 sc1
    s_waitcnt lgkmcnt(8)
    v_mfma_f32_32x32x16_bf16 v[96:111], v[40:43], a[116:119], v[96:111]
    v_mfma_f32_32x32x16_bf16 v[112:127], v[44:47], a[116:119], v[112:127]
    s_waitcnt lgkmcnt(4)
    v_mfma_f32_32x32x16_bf16 v[96:111], v[48:51], a[120:123], v[96:111]
    v_mfma_f32_32x32x16_bf16 v[112:127], v[52:55], a[120:123], v[112:127]
    s_waitcnt lgkmcnt(0)
    v_mfma_f32_32x32x16_bf16 v[96:111], v[56:59], a[124:127], v[96:111]
    v_mfma_f32_32x32x16_bf16 v[112:127], v[60:63], a[124:127], v[112:127]
    v_lshlrev_b32 v28, 3, v26
    v_add_u32 v28, 158272, v28
    ds_read_b64 v[32:33], v28 offset:0
    ds_read_b64 v[36:37], v28 offset:512
    v_mov_b32 v34, 0
    v_mov_b32 v35, 0
    v_mov_b32 v38, 0
    v_mov_b32 v39, 0
    s_lshl_b32 s54, s42, 2
    s_add_u32 s54, s54, s41
    s_mul_i32 s55, s54, 86
    s_lshl_b32 s54, s45, 1
    s_add_u32 s55, s55, s54
    s_lshl_b32 s55, s55, 10
    s_waitcnt lgkmcnt(0)
    v_xor_b32 v49, 0x80000000, v18
    v_lshrrev_b32 v49, 16, v49
    v_lshl_or_b32 v48, v49, 16, v49
    v_mov_b32 v50, 0
    v_mov_b32 v51, 0
    s_nop 1
    v_mfma_f32_32x32x16_bf16 v[96:111], v[32:35], v[48:51], v[96:111]
    s_nop 0
    v_mfma_f32_32x32x16_bf16 v[112:127], v[36:39], v[48:51], v[112:127]
    v_mul_f32 v20, v19, v19
    v_lshlrev_b32 v28, 4, v26
    s_nop 8
    v_max_f32 v96, 0, v96
    s_nop 7
    v_max_f32 v97, 0, v97
    s_nop 6
    v_max_f32 v98, 0, v98
    s_nop 5
    v_max_f32 v99, 0, v99
    s_nop 4
    v_max_f32 v100, 0, v100
    s_nop 3
    v_max_f32 v101, 0, v101
    s_nop 2
    v_max_f32 v102, 0, v102
    s_nop 1
    v_max_f32 v103, 0, v103
    s_nop 0
    v_max_f32 v104, 0, v104
    v_max_f32 v105, 0, v105
    v_max_f32 v106, 0, v106
    v_max_f32 v107, 0, v107
    v_max_f32 v108, 0, v108
    v_max_f32 v109, 0, v109
    v_max_f32 v110, 0, v110
    v_max_f32 v111, 0, v111
    v_mul_f32 v112, v20, v112
    v_mul_f32 v113, v20, v113
    v_mul_f32 v114, v20, v114
    v_mul_f32 v115, v20, v115
    v_mul_f32 v116, v20, v116
    v_mul_f32 v117, v20, v117
    v_mul_f32 v118, v20, v118
    v_mul_f32 v119, v20, v119
    v_mul_f32 v120, v20, v120
    v_mul_f32 v121, v20, v121
    v_mul_f32 v122, v20, v122
    v_mul_f32 v123, v20, v123
    v_mul_f32 v124, v20, v124
    v_mul_f32 v125, v20, v125
    v_mul_f32 v126, v20, v126
    v_mul_f32 v127, v20, v127
    v_mul_f32 v96, v96, v112
    v_mul_f32 v97, v97, v113
    v_mul_f32 v98, v98, v114
    v_mul_f32 v99, v99, v115
    v_mul_f32 v100, v100, v116
    v_mul_f32 v101, v101, v117
    v_mul_f32 v102, v102, v118
    v_mul_f32 v103, v103, v119
    v_mul_f32 v104, v104, v120
    v_mul_f32 v105, v105, v121
    v_mul_f32 v106, v106, v122
    v_mul_f32 v107, v107, v123
    v_mul_f32 v108, v108, v124
    v_mul_f32 v109, v109, v125
    v_mul_f32 v110, v110, v126
    v_mul_f32 v111, v111, v127
    v_cvt_pk_bf16_f32 v112, v96, v97
    v_cvt_pk_bf16_f32 v113, v98, v99
    v_cvt_pk_bf16_f32 v114, v100, v101
    v_cvt_pk_bf16_f32 v115, v102, v103
    v_cvt_pk_bf16_f32 v116, v104, v105
    v_cvt_pk_bf16_f32 v117, v106, v107
    v_cvt_pk_bf16_f32 v118, v108, v109
    v_cvt_pk_bf16_f32 v119, v110, v111
    s_add_u32 s54, s55, 0
    buffer_store_dwordx4 v[112:115], v28, s[20:23], s54 offen offset:0 sc1
    buffer_store_dwordx4 v[116:119], v28, s[20:23], s54 offen offset:1024 sc1
    s_add_u32 s52, s86, 24576
    buffer_load_dwordx4 a[112:115], v11, s[20:23], s52 offen offset:0 sc1
    buffer_load_dwordx4 a[116:119], v11, s[20:23], s52 offen offset:1024 sc1
    buffer_load_dwordx4 a[120:123], v11, s[20:23], s52 offen offset:2048 sc1
    buffer_load_dwordx4 a[124:127], v11, s[20:23], s52 offen offset:3072 sc1
    s_waitcnt vmcnt(4)
    s_lshl_b32 s52, s42, 2
    s_add_u32 s52, s52, s41
    s_lshl_b32 s52, s52, 8
    s_lshl_b32 s53, s43, 2
    s_add_u32 s52, s52, s53
    s_add_u32 s52, s52, 10551296
    v_mov_b32 v30, 1073741824
    v_cmp_eq_u32 vcc, 0, v26
    v_mov_b32 v31, s46
    s_nop 0
    v_cndmask_b32 v30, v30, 0, vcc
    buffer_store_dword v31, v30, s[20:23], s52 offen sc1
    v_lshrrev_b32 v31, 5, v26
    v_and_b32 v27, 15, v26
    v_bfe_u32 v28, v26, 4, 1
    v_lshlrev_b32 v27, 2, v27
    v_lshl_add_u32 v27, v28, 8, v27
    v_add_u32 v6, 128, v27
    s_lshl_b32 s54, s84, 9
    s_add_u32 s54, s54, 10551296
    v_mov_b32 v28, 157220
    s_cmp_lg_u32 s41, 0
    s_cbranch_scc1 F_FWY
    s_setprio 3
F_FPY:
    buffer_load_dword v27, v6, s[20:23], s54 offen sc1
    s_waitcnt vmcnt(0)
    v_cmp_ne_u32 vcc, s46, v27
    s_nop 1
    s_cmp_eq_u64 vcc, 0
    s_cbranch_scc1 F_FPY_OK
    s_sleep 2
    s_branch F_FPY
F_FPY_OK:
    v_mov_b32 v27, 1
    ds_write_b32 v28, v27
    s_branch F_FDY
F_FWY:
    ds_read_b32 v27, v28
    s_waitcnt lgkmcnt(0)
    v_readfirstlane_b32 s52, v27
    s_cmp_eq_u32 s52, 1
    s_cbranch_scc1 F_FDY
    s_sleep 1
    s_branch F_FWY
F_FDY:
    s_setprio 0
    s_waitcnt lgkmcnt(0)
    s_barrier
    s_add_u32 s52, s86, 28672
    buffer_load_dwordx4 a[0:3], v11, s[20:23], s52 offen offset:0 sc1
    buffer_load_dwordx4 a[4:7], v11, s[20:23], s52 offen offset:1024 sc1
    buffer_load_dwordx4 a[8:11], v11, s[20:23], s52 offen offset:2048 sc1
    buffer_load_dwordx4 a[12:15], v11, s[20:23], s52 offen offset:3072 sc1
    s_mov_b32 s16, s26
    s_mov_b32 s17, s27
    s_mov_b32 s18, 4194304
    s_mov_b32 s19, 0x00020000
    s_mov_b32 s28, s96
    s_mov_b32 s29, s97
    s_mov_b32 s30, 1024
    s_mov_b32 s31, 0x00020000
    v_mov_b32 v1, v11
    s_add_u32 s61, s87, 65536
    buffer_load_dwordx4 v[32:35], v1, s[20:23], s87 offen offset:0 sc1
    buffer_load_dwordx4 v[36:39], v1, s[20:23], s61 offen offset:0 sc1
    buffer_load_dwordx4 v[40:43], v1, s[20:23], s87 offen offset:1024 sc1
    buffer_load_dwordx4 v[44:47], v1, s[20:23], s61 offen offset:1024 sc1
    buffer_load_dwordx4 v[48:51], v1, s[20:23], s87 offen offset:2048 sc1
    buffer_load_dwordx4 v[52:55], v1, s[20:23], s61 offen offset:2048 sc1
    buffer_load_dwordx4 v[56:59], v1, s[20:23], s87 offen offset:3072 sc1
    buffer_load_dwordx4 v[60:63], v1, s[20:23], s61 offen offset:3072 sc1
    s_add_u32 s60, s87, 4096
    buffer_load_dwordx4 v[8:11], v1, s[20:23], s60 offen offset:0 sc1
    s_add_u32 s60, s61, 4096
    buffer_load_dwordx4 v[12:15], v1, s[20:23], s60 offen offset:0 sc1
    s_add_u32 s60, s87, 4096
    buffer_load_dwordx4 v[16:19], v1, s[20:23], s60 offen offset:1024 sc1
    s_add_u32 s60, s61, 4096
    buffer_load_dwordx4 v[20:23], v1, s[20:23], s60 offen offset:1024 sc1
    s_waitcnt vmcnt(10)
    v_mfma_f32_32x32x16_bf16 v[64:79], v[32:35], a[16:19], 0
    v_mfma_f32_32x32x16_bf16 v[96:111], v[36:39], a[16:19], 0
    v_mfma_f32_32x32x16_bf16 v[80:95], v[32:35], a[32:35], 0
    v_mfma_f32_32x32x16_bf16 v[112:127], v[36:39], a[32:35], 0
    s_add_u32 s60, s87, 4096
    buffer_load_dwordx4 v[32:35], v1, s[20:23], s60 offen offset:2048 sc1
    s_add_u32 s60, s61, 4096
    buffer_load_dwordx4 v[36:39], v1, s[20:23], s60 offen offset:2048 sc1
    s_waitcnt vmcnt(10)
    v_mfma_f32_32x32x16_bf16 v[64:79], v[40:43], a[20:23], v[64:79]
    v_mfma_f32_32x32x16_bf16 v[96:111], v[44:47], a[20:23], v[96:111]
    v_mfma_f32_32x32x16_bf16 v[80:95], v[40:43], a[36:39], v[80:95]
    v_mfma_f32_32x32x16_bf16 v[112:127], v[44:47], a[36:39], v[112:127]
    s_add_u32 s60, s87, 4096
    buffer_load_dwordx4 v[40:43], v1, s[20:23], s60 offen offset:3072 sc1
    s_add_u32 s60, s61, 4096
    buffer_load_dwordx4 v[44:47], v1, s[20:23], s60 offen offset:3072 sc1
    s_waitcnt vmcnt(10)
    v_mfma_f32_32x32x16_bf16 v[64:79], v[48:51], a[24:27], v[64:79]
    v_mfma_f32_32x32x16_bf16 v[96:111], v[52:55], a[24:27], v[96:111]
    v_mfma_f32_32x32x16_bf16 v[80:95], v[48:51], a[40:43], v[80:95]
    v_mfma_f32_32x32x16_bf16 v[112:127], v[52:55], a[40:43], v[112:127]
    s_add_u32 s60, s87, 8192
    buffer_load_dwordx4 v[48:51], v1, s[20:23], s60 offen offset:0 sc1
    s_add_u32 s60, s61, 8192
    buffer_load_dwordx4 v[52:55], v1, s[20:23], s60 offen offset:0 sc1
    s_waitcnt vmcnt(10)
    v_mfma_f32_32x32x16_bf16 v[64:79], v[56:59], a[28:31], v[64:79]
    v_mfma_f32_32x32x16_bf16 v[96:111], v[60:63], a[28:31], v[96:111]
    v_mfma_f32_32x32x16_bf16 v[80:95], v[56:59], a[44:47], v[80:95]
    v_mfma_f32_32x32x16_bf16 v[112:127], v[60:63], a[44:47], v[112:127]
    s_add_u32 s60, s87, 8192
    buffer_load_dwordx4 v[56:59], v1, s[20:23], s60 offen offset:1024 sc1
    s_add_u32 s60, s61, 8192
    buffer_load_dwordx4 v[60:63], v1, s[20:23], s60 offen offset:1024 sc1
    s_waitcnt vmcnt(10)
    v_mfma_f32_32x32x16_bf16 v[64:79], v[8:11], a[48:51], v[64:79]
    v_mfma_f32_32x32x16_bf16 v[96:111], v[12:15], a[48:51], v[96:111]
    v_mfma_f32_32x32x16_bf16 v[80:95], v[8:11], a[64:67], v[80:95]
    v_mfma_f32_32x32x16_bf16 v[112:127], v[12:15], a[64:67], v[112:127]
    s_add_u32 s60, s87, 8192
    buffer_load_dwordx4 v[8:11], v1, s[20:23], s60 offen offset:2048 sc1
    s_add_u32 s60, s61, 8192
    buffer_load_dwordx4 v[12:15], v1, s[20:23], s60 offen offset:2048 sc1
    s_waitcnt vmcnt(10)
    v_mfma_f32_32x32x16_bf16 v[64:79], v[16:19], a[52:55], v[64:79]
    v_mfma_f32_32x32x16_bf16 v[96:111], v[20:23], a[52:55], v[96:111]
    v_mfma_f32_32x32x16_bf16 v[80:95], v[16:19], a[68:71], v[80:95]
    v_mfma_f32_32x32x16_bf16 v[112:127], v[20:23], a[68:71], v[112:127]
    s_add_u32 s60, s87, 8192
    buffer_load_dwordx4 v[16:19], v1, s[20:23], s60 offen offset:3072 sc1
    s_add_u32 s60, s61, 8192
    buffer_load_dwordx4 v[20:23], v1, s[20:23], s60 offen offset:3072 sc1
    s_waitcnt vmcnt(10)
    v_mfma_f32_32x32x16_bf16 v[64:79], v[32:35], a[56:59], v[64:79]
    v_mfma_f32_32x32x16_bf16 v[96:111], v[36:39], a[56:59], v[96:111]
    v_mfma_f32_32x32x16_bf16 v[80:95], v[32:35], a[72:75], v[80:95]
    v_mfma_f32_32x32x16_bf16 v[112:127], v[36:39], a[72:75], v[112:127]
    s_add_u32 s60, s87, 12288
    buffer_load_dwordx4 v[32:35], v1, s[20:23], s60 offen offset:0 sc1
    s_add_u32 s60, s61, 12288
    buffer_load_dwordx4 v[36:39], v1, s[20:23], s60 offen offset:0 sc1
    s_waitcnt vmcnt(10)
    v_mfma_f32_32x32x16_bf16 v[64:79], v[40:43], a[60:63], v[64:79]
    v_mfma_f32_32x32x16_bf16 v[96:111], v[44:47], a[60:63], v[96:111]
    v_mfma_f32_32x32x16_bf16 v[80:95], v[40:43], a[76:79], v[80:95]
    v_mfma_f32_32x32x16_bf16 v[112:127], v[44:47], a[76:79], v[112:127]
    s_add_u32 s60, s87, 12288
    buffer_load_dwordx4 v[40:43], v1, s[20:23], s60 offen offset:1024 sc1
    s_add_u32 s60, s61, 12288
    buffer_load_dwordx4 v[44:47], v1, s[20:23], s60 offen offset:1024 sc1
    s_waitcnt vmcnt(10)
    v_mfma_f32_32x32x16_bf16 v[64:79], v[48:51], a[80:83], v[64:79]
    v_mfma_f32_32x32x16_bf16 v[96:111], v[52:55], a[80:83], v[96:111]
    v_mfma_f32_32x32x16_bf16 v[80:95], v[48:51], a[96:99], v[80:95]
    v_mfma_f32_32x32x16_bf16 v[112:127], v[52:55], a[96:99], v[112:127]
    s_add_u32 s60, s87, 12288
    buffer_load_dwordx4 v[48:51], v1, s[20:23], s60 offen offset:2048 sc1
    s_add_u32 s60, s61, 12288
    buffer_load_dwordx4 v[52:55], v1, s[20:23], s60 offen offset:2048 sc1
    s_waitcnt vmcnt(10)
    v_mfma_f32_32x32x16_bf16 v[64:79], v[56:59], a[84:87], v[64:79]
    v_mfma_f32_32x32x16_bf16 v[96:111], v[60:63], a[84:87], v[96:111]
    v_mfma_f32_32x32x16_bf16 v[80:95], v[56:59], a[100:103], v[80:95]
    v_mfma_f32_32x32x16_bf16 v[112:127], v[60:63], a[100:103], v[112:127]
    s_add_u32 s60, s87, 12288
    buffer_load_dwordx4 v[56:59], v1, s[20:23], s60 offen offset:3072 sc1
    s_add_u32 s60, s61, 12288
    buffer_load_dwordx4 v[60:63], v1, s[20:23], s60 offen offset:3072 sc1
    s_waitcnt vmcnt(10)
    v_mfma_f32_32x32x16_bf16 v[64:79], v[8:11], a[88:91], v[64:79]
    v_mfma_f32_32x32x16_bf16 v[96:111], v[12:15], a[88:91], v[96:111]
    v_mfma_f32_32x32x16_bf16 v[80:95], v[8:11], a[104:107], v[80:95]
    v_mfma_f32_32x32x16_bf16 v[112:127], v[12:15], a[104:107], v[112:127]
    s_waitcnt vmcnt(8)
    v_mfma_f32_32x32x16_bf16 v[64:79], v[16:19], a[92:95], v[64:79]
    v_mfma_f32_32x32x16_bf16 v[96:111], v[20:23], a[92:95], v[96:111]
    v_mfma_f32_32x32x16_bf16 v[80:95], v[16:19], a[108:111], v[80:95]
    v_mfma_f32_32x32x16_bf16 v[112:127], v[20:23], a[108:111], v[112:127]
    v_and_b32 v27, 31, v26
    v_lshrrev_b32 v31, 5, v26
    s_lshl_b32 s52, s84, 6
    s_lshr_b32 s53, s40, 2
    s_lshl_b32 s53, s53, 5
    s_add_u32 s52, s52, s53
    s_and_b32 s53, s40, 1
    s_lshl_b32 s53, s53, 3
    s_add_u32 s52, s52, s53
    s_lshl_b32 s53, s85, 6
    s_bfe_u32 s54, s40, 0x10001
    s_lshl_b32 s54, s54, 5
    s_add_u32 s53, s53, s54
    v_lshl_add_u32 v28, v31, 4, s52
    v_add_u32 v29, s53, v27
    v_lshl_add_u32 v30, v28, 9, v29
    v_lshlrev_b32 v17, 2, v30
    v_lshlrev_b32 v30, 1, v30
    buffer_load_ushort v8, v30, s[8:11], 0 offen offset:0
    buffer_load_ushort v9, v30, s[8:11], 0 offen offset:1024
    buffer_load_ushort v10, v30, s[8:11], 0 offen offset:2048
    buffer_load_ushort v11, v30, s[8:11], 0 offen offset:3072
    s_movk_i32 s54, 0x1000
    buffer_load_ushort v12, v30, s[8:11], s54 offen offset:0
    buffer_load_ushort v13, v30, s[8:11], s54 offen offset:1024
    buffer_load_ushort v14, v30, s[8:11], s54 offen offset:2048
    buffer_load_ushort v15, v30, s[8:11], s54 offen offset:3072
    v_lshlrev_b32 v29, 1, v29
    buffer_load_ushort v16, v29, s[28:31], 0 offen
    v_lshlrev_b32 v19, 3, v28
    s_waitcnt vmcnt(15)
    v_mfma_f32_32x32x16_bf16 v[64:79], v[32:35], a[112:115], v[64:79]
    v_mfma_f32_32x32x16_bf16 v[96:111], v[36:39], a[112:115], v[96:111]
    v_mfma_f32_32x32x16_bf16 v[80:95], v[32:35], a[0:3], v[80:95]
    v_mfma_f32_32x32x16_bf16 v[112:127], v[36:39], a[0:3], v[112:127]
    s_waitcnt vmcnt(13)
    v_mfma_f32_32x32x16_bf16 v[64:79], v[40:43], a[116:119], v[64:79]
    v_mfma_f32_32x32x16_bf16 v[96:111], v[44:47], a[116:119], v[96:111]
    v_mfma_f32_32x32x16_bf16 v[80:95], v[40:43], a[4:7], v[80:95]
    v_mfma_f32_32x32x16_bf16 v[112:127], v[44:47], a[4:7], v[112:127]
    s_mov_b32 s55, 10485760
    buffer_load_dwordx4 v[32:35], v19, s[20:23], s55 offen offset:0 sc1
    buffer_load_dwordx4 v[36:39], v19, s[20:23], s55 offen offset:16 sc1
    buffer_load_dwordx4 v[40:43], v19, s[20:23], s55 offen offset:32 sc1
    buffer_load_dwordx4 v[44:47], v19, s[20:23], s55 offen offset:48 sc1
    s_waitcnt vmcnt(15)
    v_mfma_f32_32x32x16_bf16 v[64:79], v[48:51], a[120:123], v[64:79]
    v_mfma_f32_32x32x16_bf16 v[96:111], v[52:55], a[120:123], v[96:111]
    v_mfma_f32_32x32x16_bf16 v[80:95], v[48:51], a[8:11], v[80:95]
    v_mfma_f32_32x32x16_bf16 v[112:127], v[52:55], a[8:11], v[112:127]
    s_waitcnt vmcnt(13)
    v_mfma_f32_32x32x16_bf16 v[64:79], v[56:59], a[124:127], v[64:79]
    v_mfma_f32_32x32x16_bf16 v[96:111], v[60:63], a[124:127], v[96:111]
    v_mfma_f32_32x32x16_bf16 v[80:95], v[56:59], a[12:15], v[80:95]
    v_mfma_f32_32x32x16_bf16 v[112:127], v[60:63], a[12:15], v[112:127]
    s_branch F_RED
F_Z:
RESET_z:
    s_add_u32 s60, s101, 0
    s_and_b32 s60, s60, 7
    s_lshl_b32 s60, s60, 7
    s_add_u32 s61, s60, s48
    s_add_u32 m0, s56, 2048
    s_add_u32 s63, s61, 8192
    buffer_load_dwordx4 v11, s[8:11], s63 offen  lds
    s_add_u32 m0, s56, 3072
    s_add_u32 s63, s61, 12288
    buffer_load_dwordx4 v12, s[8:11], s63 offen  lds
    s_lshl_b32 s62, s44, 1
    s_add_u32 s62, s62, 0
    s_and_b32 s62, s62, 15
    s_mul_i32 s62, s62, 88064
    s_add_u32 s62, s62, s50
    s_add_u32 m0, s58, 98304
    s_nop 0
    buffer_load_dwordx4 v15, s[16:19], s62 offen  lds
    s_add_u32 m0, s58, 99328
    s_nop 0
    buffer_load_dwordx4 v16, s[16:19], s62 offen  lds
    s_add_u32 m0, s58, 100352
    s_nop 0
    buffer_load_dwordx4 v17, s[16:19], s62 offen  lds
    s_lshl_b32 s47, s43, 1
    s_lshr_b32 s54, s42, 3
    s_add_u32 s47, s47, s54
    s_lshl_b32 s47, s47, 14
    s_add_u32 s47, s47, 12058624
    s_lshl_b32 s98, s42, 2
    s_lshr_b32 s54, s43, 2
    s_add_u32 s98, s98, s54
    s_lshl_b32 s98, s98, 2
    s_add_u32 s98, s98, s41
    s_lshl_b32 s98, s98, 11
    s_add_u32 s98, s98, 11010048
    v_lshrrev_b32 v29, 5, v26
    v_and_b32 v30, 31, v26
    v_bfe_u32 v31, v26, 1, 3
    v_xor_b32 v31, v31, v29
    v_lshlrev_b32 v31, 4, v31
    v_lshl_add_u32 v30, v30, 7, v31
    v_add_u32 v1, s56, v30
    v_add_u32 v5, 65536, v30
    v_xor_b32 v2, 32, v1
    v_xor_b32 v6, 32, v5
    v_xor_b32 v3, 64, v1
    v_xor_b32 v7, 64, v5
    v_xor_b32 v4, 96, v1
    v_xor_b32 v8, 96, v5
    v_bfe_u32 v30, v26, 2, 2
    v_lshl_add_u32 v30, v29, 3, v30
    v_mul_u32_u24 v30, 192, v30
    v_bfe_u32 v31, v26, 4, 1
    v_lshl_add_u32 v30, v31, 5, v30
    v_and_b32 v31, 3, v26
    v_lshl_add_u32 v10, v31, 3, v30
    v_add_u32 v9, 86016, v10
    v_mov_b32 v22, s59
    v_mov_b32 v23, 0x3f803f80
    v_mov_b32 v18, 0
    v_mov_b32 v19, 0
    v_mov_b32 v20, 0
    v_mov_b32 v21, 0
    v_mov_b32 v24, 0
    v_mov_b32 v25, 0
    v_mov_b32 v64, 0
    v_mov_b32 v65, 0
    v_mov_b32 v66, 0
    v_mov_b32 v67, 0
    v_mov_b32 v68, 0
    v_mov_b32 v69, 0
    v_mov_b32 v70, 0
    v_mov_b32 v71, 0
    v_mov_b32 v72, 0
    v_mov_b32 v73, 0
    v_mov_b32 v74, 0
    v_mov_b32 v75, 0
    v_mov_b32 v76, 0
    v_mov_b32 v77, 0
    v_mov_b32 v78, 0
    v_mov_b32 v79, 0
    v_mov_b32 v80, 0
    v_mov_b32 v81, 0
    v_mov_b32 v82, 0
    v_mov_b32 v83, 0
    v_mov_b32 v84, 0
    v_mov_b32 v85, 0
    v_mov_b32 v86, 0
    v_mov_b32 v87, 0
    v_mov_b32 v88, 0
    v_mov_b32 v89, 0
    v_mov_b32 v90, 0
    v_mov_b32 v91, 0
    v_mov_b32 v92, 0
    v_mov_b32 v93, 0
    v_mov_b32 v94, 0
    v_mov_b32 v95, 0
    v_mov_b32 v96, 0
    v_mov_b32 v97, 0
    v_mov_b32 v98, 0
    v_mov_b32 v99, 0
    v_mov_b32 v100, 0
    v_mov_b32 v101, 0
    v_mov_b32 v102, 0
    v_mov_b32 v103, 0
    v_mov_b32 v104, 0
    v_mov_b32 v105, 0
    v_mov_b32 v106, 0
    v_mov_b32 v107, 0
    v_mov_b32 v108, 0
    v_mov_b32 v109, 0
    v_mov_b32 v110, 0
    v_mov_b32 v111, 0
    v_mov_b32 v112, 0
    v_mov_b32 v113, 0
    v_mov_b32 v114, 0
    v_mov_b32 v115, 0
    v_mov_b32 v116, 0
    v_mov_b32 v117, 0
    v_mov_b32 v118, 0
    v_mov_b32 v119, 0
    v_mov_b32 v120, 0
    v_mov_b32 v121, 0
    v_mov_b32 v122, 0
    v_mov_b32 v123, 0
    v_mov_b32 v124, 0
    v_mov_b32 v125, 0
    v_mov_b32 v126, 0
    v_mov_b32 v127, 0
    s_add_u32 s60, s101, 1
    s_and_b32 s60, s60, 7
    s_lshl_b32 s60, s60, 7
    s_add_u32 s61, s60, s48
    s_add_u32 m0, s56, 18432
    s_add_u32 s63, s61, 8192
    buffer_load_dwordx4 v11, s[8:11], s63 offen  lds
    s_add_u32 m0, s56, 19456
    s_add_u32 s63, s61, 12288
    buffer_load_dwordx4 v12, s[8:11], s63 offen  lds
    s_lshl_b32 s62, s44, 1
    s_add_u32 s62, s62, 1
    s_and_b32 s62, s62, 15
    s_mul_i32 s62, s62, 88064
    s_add_u32 s62, s62, s50
    s_add_u32 m0, s58, 110592
    s_nop 0
    buffer_load_dwordx4 v15, s[16:19], s62 offen  lds
    s_add_u32 m0, s58, 111616
    s_nop 0
    buffer_load_dwordx4 v16, s[16:19], s62 offen  lds
    s_add_u32 m0, s58, 112640
    s_nop 0
    buffer_load_dwordx4 v17, s[16:19], s62 offen  lds
    s_waitcnt lgkmcnt(0)
    s_mul_i32 s46, s46, 0x9E3779B1
    s_add_u32 s46, s46, 0x7F4A7C15
    s_and_b32 s52, s2, 7
    s_lshr_b32 s53, s2, 3
    s_and_b32 s54, s53, 3
    s_lshl_b32 s84, s52, 2
    s_add_u32 s84, s84, s54
    s_lshr_b32 s85, s53, 2
    v_mov_b32 v27, 157184
    ds_write_b128 v27, v[64:67]
    ds_write_b128 v27, v[64:67] offset:16
    ds_write_b128 v27, v[64:67] offset:32
    s_waitcnt vmcnt(5)
    s_waitcnt lgkmcnt(0)
    s_barrier
    ds_read_b128 a[0:3], v1 offset:0
    ds_read_b128 a[4:7], v2 offset:0
    ds_read_b128 a[8:11], v3 offset:0
    ds_read_b128 a[12:15], v4 offset:0
    ds_read_b64_tr_b16 v[32:33], v9 offset:12352
    ds_read_b64_tr_b16 v[34:35], v9 offset:13120
    ds_read_b64_tr_b16 v[36:37], v9 offset:18496
    ds_read_b64_tr_b16 v[38:39], v9 offset:19264
    ds_read_b64_tr_b16 v[40:41], v9 offset:12416
    ds_read_b64_tr_b16 v[42:43], v9 offset:13184
    ds_read_b64_tr_b16 v[44:45], v9 offset:18560
    ds_read_b64_tr_b16 v[46:47], v9 offset:19328
    ds_read_b64_tr_b16 v[48:49], v9 offset:15424
    ds_read_b64_tr_b16 v[50:51], v9 offset:16192
    ds_read_b64_tr_b16 v[52:53], v9 offset:21568
    ds_read_b64_tr_b16 v[54:55], v9 offset:22336
    ds_read_b64_tr_b16 v[56:57], v9 offset:15488
    ds_read_b64_tr_b16 v[58:59], v9 offset:16256
    ds_read_b64_tr_b16 v[60:61], v9 offset:21632
    ds_read_b64_tr_b16 v[62:63], v9 offset:22400
    s_waitcnt lgkmcnt(12)
    v_mfma_f32_32x32x16_bf16 v[64:79], v[32:35], a[0:3], v[64:79]
    v_mfma_f32_32x32x16_bf16 v[80:95], v[36:39], a[0:3], v[80:95]
    s_cmp_eq_u32 s41, 0
    s_cbranch_scc0 F_cw17
    v_dot2c_f32_bf16 v24, v23, v32
    v_dot2c_f32_bf16 v25, v23, v33
    v_dot2c_f32_bf16 v24, v23, v34
    v_dot2c_f32_bf16 v25, v23, v35
F_cw17:
    s_cmp_eq_u32 s41, 1
    s_cbranch_scc0 F_cw18
    v_dot2c_f32_bf16 v24, v23, v36
    v_dot2c_f32_bf16 v25, v23, v37
    v_dot2c_f32_bf16 v24, v23, v38
    v_dot2c_f32_bf16 v25, v23, v39
F_cw18:
    ds_read_b128 v[32:35], v1 offset:0
    ds_read_b128 v[36:39], v2 offset:0
    s_waitcnt lgkmcnt(10)
    v_mfma_f32_32x32x16_bf16 v[96:111], v[40:43], a[0:3], v[96:111]
    v_mfma_f32_32x32x16_bf16 v[112:127], v[44:47], a[0:3], v[112:127]
    s_cmp_eq_u32 s41, 2
    s_cbranch_scc0 F_cw19
    v_dot2c_f32_bf16 v24, v23, v40
    v_dot2c_f32_bf16 v25, v23, v41
    v_dot2c_f32_bf16 v24, v23, v42
    v_dot2c_f32_bf16 v25, v23, v43
F_cw19:
    s_cmp_eq_u32 s41, 3
    s_cbranch_scc0 F_cw20
    v_dot2c_f32_bf16 v24, v23, v44
    v_dot2c_f32_bf16 v25, v23, v45
    v_dot2c_f32_bf16 v24, v23, v46
    v_dot2c_f32_bf16 v25, v23, v47
F_cw20:
    ds_read_b128 v[40:43], v3 offset:0
    ds_read_b128 v[44:47], v4 offset:0
    s_waitcnt lgkmcnt(8)
    v_mfma_f32_32x32x16_bf16 v[64:79], v[48:51], a[4:7], v[64:79]
    v_mfma_f32_32x32x16_bf16 v[80:95], v[52:55], a[4:7], v[80:95]
    s_cmp_eq_u32 s41, 0
    s_cbranch_scc0 F_cw21
    v_dot2c_f32_bf16 v24, v23, v48
    v_dot2c_f32_bf16 v25, v23, v49
    v_dot2c_f32_bf16 v24, v23, v50
    v_dot2c_f32_bf16 v25, v23, v51
F_cw21:
    s_cmp_eq_u32 s41, 1
    s_cbranch_scc0 F_cw22
    v_dot2c_f32_bf16 v24, v23, v52
    v_dot2c_f32_bf16 v25, v23, v53
    v_dot2c_f32_bf16 v24, v23, v54
    v_dot2c_f32_bf16 v25, v23, v55
F_cw22:
    s_waitcnt lgkmcnt(4)
    v_mfma_f32_32x32x16_bf16 v[96:111], v[56:59], a[4:7], v[96:111]
    v_mfma_f32_32x32x16_bf16 v[112:127], v[60:63], a[4:7], v[112:127]
    s_cmp_eq_u32 s41, 2
    s_cbranch_scc0 F_cw23
    v_dot2c_f32_bf16 v24, v23, v56
    v_dot2c_f32_bf16 v25, v23, v57
    v_dot2c_f32_bf16 v24, v23, v58
    v_dot2c_f32_bf16 v25, v23, v59
F_cw23:
    s_cmp_eq_u32 s41, 3
    s_cbranch_scc0 F_cw24
    v_dot2c_f32_bf16 v24, v23, v60
    v_dot2c_f32_bf16 v25, v23, v61
    v_dot2c_f32_bf16 v24, v23, v62
    v_dot2c_f32_bf16 v25, v23, v63
F_cw24:
    s_waitcnt lgkmcnt(3)
    v_dot2c_f32_bf16 v18, v23, v32
    v_dot2c_f32_bf16 v19, v32, v32
    v_dot2c_f32_bf16 v20, v23, v33
    v_dot2c_f32_bf16 v21, v33, v33
    v_dot2c_f32_bf16 v18, v23, v34
    v_dot2c_f32_bf16 v19, v34, v34
    v_dot2c_f32_bf16 v20, v23, v35
    v_dot2c_f32_bf16 v21, v35, v35
    s_waitcnt lgkmcnt(2)
    v_dot2c_f32_bf16 v18, v23, v36
    v_dot2c_f32_bf16 v19, v36, v36
    v_dot2c_f32_bf16 v20, v23, v37
    v_dot2c_f32_bf16 v21, v37, v37
    v_dot2c_f32_bf16 v18, v23, v38
    v_dot2c_f32_bf16 v19, v38, v38
    v_dot2c_f32_bf16 v20, v23, v39
    v_dot2c_f32_bf16 v21, v39, v39
    s_waitcnt vmcnt(0)
    s_waitcnt lgkmcnt(0)
    s_barrier
    ds_read_b128 a[16:19], v1 offset:16384
    ds_read_b128 a[20:23], v2 offset:16384
    ds_read_b128 a[24:27], v3 offset:16384
    ds_read_b128 a[28:31], v4 offset:16384
    ds_read_b64_tr_b16 v[48:49], v9 offset:24640
    ds_read_b64_tr_b16 v[50:51], v9 offset:25408
    ds_read_b64_tr_b16 v[52:53], v9 offset:30784
    ds_read_b64_tr_b16 v[54:55], v9 offset:31552
    ds_read_b64_tr_b16 v[56:57], v9 offset:24704
    ds_read_b64_tr_b16 v[58:59], v9 offset:25472
    ds_read_b64_tr_b16 v[60:61], v9 offset:30848
    ds_read_b64_tr_b16 v[62:63], v9 offset:31616
    ds_read_b64_tr_b16 v[32:33], v9 offset:27712
    ds_read_b64_tr_b16 v[34:35], v9 offset:28480
    ds_read_b64_tr_b16 v[36:37], v9 offset:33856
    ds_read_b64_tr_b16 v[38:39], v9 offset:34624
    v_dot2c_f32_bf16 v18, v23, v40
    v_dot2c_f32_bf16 v19, v40, v40
    v_dot2c_f32_bf16 v20, v23, v41
    v_dot2c_f32_bf16 v21, v41, v41
    v_dot2c_f32_bf16 v18, v23, v42
    v_dot2c_f32_bf16 v19, v42, v42
    v_dot2c_f32_bf16 v20, v23, v43
    v_dot2c_f32_bf16 v21, v43, v43
    v_dot2c_f32_bf16 v18, v23, v44
    v_dot2c_f32_bf16 v19, v44, v44
    v_dot2c_f32_bf16 v20, v23, v45
    v_dot2c_f32_bf16 v21, v45, v45
    v_dot2c_f32_bf16 v18, v23, v46
    v_dot2c_f32_bf16 v19, v46, v46
    v_dot2c_f32_bf16 v20, v23, v47
    v_dot2c_f32_bf16 v21, v47, v47
    ds_read_b64_tr_b16 v[40:41], v9 offset:27776
    ds_read_b64_tr_b16 v[42:43], v9 offset:28544
    ds_read_b64_tr_b16 v[44:45], v9 offset:33920
    ds_read_b64_tr_b16 v[46:47], v9 offset:34688
    s_waitcnt lgkmcnt(12)
    v_mfma_f32_32x32x16_bf16 v[64:79], v[48:51], a[8:11], v[64:79]
    v_mfma_f32_32x32x16_bf16 v[80:95], v[52:55], a[8:11], v[80:95]
    s_cmp_eq_u32 s41, 0
    s_cbranch_scc0 F_cw25
    v_dot2c_f32_bf16 v24, v23, v48
    v_dot2c_f32_bf16 v25, v23, v49
    v_dot2c_f32_bf16 v24, v23, v50
    v_dot2c_f32_bf16 v25, v23, v51
F_cw25:
    s_cmp_eq_u32 s41, 1
    s_cbranch_scc0 F_cw26
    v_dot2c_f32_bf16 v24, v23, v52
    v_dot2c_f32_bf16 v25, v23, v53
    v_dot2c_f32_bf16 v24, v23, v54
    v_dot2c_f32_bf16 v25, v23, v55
F_cw26:
    ds_read_b128 v[48:51], v1 offset:16384
    ds_read_b128 v[52:55], v2 offset:16384
    s_waitcnt lgkmcnt(10)
    v_mfma_f32_32x32x16_bf16 v[96:111], v[56:59], a[8:11], v[96:111]
    v_mfma_f32_32x32x16_bf16 v[112:127], v[60:63], a[8:11], v[112:127]
    s_cmp_eq_u32 s41, 2
    s_cbranch_scc0 F_cw27
    v_dot2c_f32_bf16 v24, v23, v56
    v_dot2c_f32_bf16 v25, v23, v57
    v_dot2c_f32_bf16 v24, v23, v58
    v_dot2c_f32_bf16 v25, v23, v59
F_cw27:
    s_cmp_eq_u32 s41, 3
    s_cbranch_scc0 F_cw28
    v_dot2c_f32_bf16 v24, v23, v60
    v_dot2c_f32_bf16 v25, v23, v61
    v_dot2c_f32_bf16 v24, v23, v62
    v_dot2c_f32_bf16 v25, v23, v63
F_cw28:
    ds_read_b128 v[56:59], v3 offset:16384
    ds_read_b128 v[60:63], v4 offset:16384
    s_waitcnt lgkmcnt(8)
    v_mfma_f32_32x32x16_bf16 v[64:79], v[32:35], a[12:15], v[64:79]
    v_mfma_f32_32x32x16_bf16 v[80:95], v[36:39], a[12:15], v[80:95]
    s_cmp_eq_u32 s41, 0
    s_cbranch_scc0 F_cw29
    v_dot2c_f32_bf16 v24, v23, v32
    v_dot2c_f32_bf16 v25, v23, v33
    v_dot2c_f32_bf16 v24, v23, v34
    v_dot2c_f32_bf16 v25, v23, v35
F_cw29:
    s_cmp_eq_u32 s41, 1
    s_cbranch_scc0 F_cw30
    v_dot2c_f32_bf16 v24, v23, v36
    v_dot2c_f32_bf16 v25, v23, v37
    v_dot2c_f32_bf16 v24, v23, v38
    v_dot2c_f32_bf16 v25, v23, v39
F_cw30:
    s_waitcnt lgkmcnt(4)
    v_mfma_f32_32x32x16_bf16 v[96:111], v[40:43], a[12:15], v[96:111]
    v_mfma_f32_32x32x16_bf16 v[112:127], v[44:47], a[12:15], v[112:127]
    s_cmp_eq_u32 s41, 2
    s_cbranch_scc0 F_cw31
    v_dot2c_f32_bf16 v24, v23, v40
    v_dot2c_f32_bf16 v25, v23, v41
    v_dot2c_f32_bf16 v24, v23, v42
    v_dot2c_f32_bf16 v25, v23, v43
F_cw31:
    s_cmp_eq_u32 s41, 3
    s_cbranch_scc0 F_cw32
    v_dot2c_f32_bf16 v24, v23, v44
    v_dot2c_f32_bf16 v25, v23, v45
    v_dot2c_f32_bf16 v24, v23, v46
    v_dot2c_f32_bf16 v25, v23, v47
F_cw32:
    s_waitcnt lgkmcnt(3)
    v_dot2c_f32_bf16 v18, v23, v48
    v_dot2c_f32_bf16 v19, v48, v48
    v_dot2c_f32_bf16 v20, v23, v49
    v_dot2c_f32_bf16 v21, v49, v49
    v_dot2c_f32_bf16 v18, v23, v50
    v_dot2c_f32_bf16 v19, v50, v50
    v_dot2c_f32_bf16 v20, v23, v51
    v_dot2c_f32_bf16 v21, v51, v51
    s_waitcnt lgkmcnt(2)
    v_dot2c_f32_bf16 v18, v23, v52
    v_dot2c_f32_bf16 v19, v52, v52
    v_dot2c_f32_bf16 v20, v23, v53
    v_dot2c_f32_bf16 v21, v53, v53
    v_dot2c_f32_bf16 v18, v23, v54
    v_dot2c_f32_bf16 v19, v54, v54
    v_dot2c_f32_bf16 v20, v23, v55
    v_dot2c_f32_bf16 v21, v55, v55
    s_waitcnt lgkmcnt(1)
    v_dot2c_f32_bf16 v18, v23, v56
    v_dot2c_f32_bf16 v19, v56, v56
    v_dot2c_f32_bf16 v20, v23, v57
    v_dot2c_f32_bf16 v21, v57, v57
    v_dot2c_f32_bf16 v18, v23, v58
    v_dot2c_f32_bf16 v19, v58, v58
    v_dot2c_f32_bf16 v20, v23, v59
    v_dot2c_f32_bf16 v21, v59, v59
    s_waitcnt lgkmcnt(0)
    v_dot2c_f32_bf16 v18, v23, v60
    v_dot2c_f32_bf16 v19, v60, v60
    v_dot2c_f32_bf16 v20, v23, v61
    v_dot2c_f32_bf16 v21, v61, v61
    v_dot2c_f32_bf16 v18, v23, v62
    v_dot2c_f32_bf16 v19, v62, v62
    v_dot2c_f32_bf16 v20, v23, v63
    v_dot2c_f32_bf16 v21, v63, v63
    v_add_f32 v24, v24, v25
    s_nop 0
    v_add_f32 v18, v18, v20
    s_nop 0
    v_add_f32 v19, v19, v21
    v_mov_b32 v25, v24
    s_nop 1
    v_permlane32_swap_b32 v24, v25
    v_add_f32 v24, v24, v25
    v_mov_b32 v28, v18
    s_nop 1
    v_permlane32_swap_b32 v18, v28
    v_add_f32 v18, v18, v28
    v_mov_b32 v29, v19
    s_nop 1
    v_permlane32_swap_b32 v19, v29
    v_add_f32 v19, v19, v29
    v_mov_b32 v20, v24
    s_lshl_b32 s52, s41, 10
    s_add_u32 s52, s52, 158272
    v_lshl_add_u32 v27, v26, 4, s52
    ds_write_b128 v27, v[18:21]
    s_add_u32 s52, s41, 2
    s_lshl_b32 s52, s52, 11
    s_add_u32 s47, s47, s52
    s_waitcnt lgkmcnt(0)
    s_barrier
    ds_read_b128 a[32:35], v1 offset:32768
    ds_read_b128 a[36:39], v2 offset:32768
    ds_read_b128 a[40:43], v3 offset:32768
    ds_read_b128 a[44:47], v4 offset:32768
    s_add_u32 s60, s101, 5
    s_and_b32 s60, s60, 7
    s_lshl_b32 s60, s60, 7
    s_add_u32 s61, s60, s48
    s_add_u32 m0, s56, 16384
    s_add_u32 s63, s61, 0
    buffer_load_dwordx4 v11, s[8:11], s63 offen  lds
    s_add_u32 m0, s56, 17408
    s_add_u32 s63, s61, 4096
    buffer_load_dwordx4 v12, s[8:11], s63 offen  lds
    s_add_u32 m0, s56, 18432
    s_add_u32 s63, s61, 8192
    buffer_load_dwordx4 v11, s[8:11], s63 offen  lds
    s_add_u32 m0, s56, 19456
    s_add_u32 s63, s61, 12288
    buffer_load_dwordx4 v12, s[8:11], s63 offen  lds
    s_add_u32 m0, s57, 8192
    s_add_u32 s63, s60, s49
    buffer_load_dwordx4 v13, s[12:15], s63 offen  lds
    s_add_u32 m0, s57, 9216
    s_add_u32 s63, s60, s49
    s_add_u32 s63, s63, 8192
    buffer_load_dwordx4 v14, s[12:15], s63 offen  lds
    s_waitcnt lgkmcnt(0)
    s_barrier
    ds_read_b128 a[48:51], v1 offset:49152
    ds_read_b128 a[52:55], v2 offset:49152
    ds_read_b128 a[56:59], v3 offset:49152
    ds_read_b128 a[60:63], v4 offset:49152
    s_add_u32 s60, s101, 6
    s_and_b32 s60, s60, 7
    s_lshl_b32 s60, s60, 7
    s_add_u32 s61, s60, s48
    s_add_u32 m0, s56, 32768
    s_add_u32 s63, s61, 0
    buffer_load_dwordx4 v11, s[8:11], s63 offen  lds
    s_add_u32 m0, s56, 33792
    s_add_u32 s63, s61, 4096
    buffer_load_dwordx4 v12, s[8:11], s63 offen  lds
    s_add_u32 m0, s56, 34816
    s_add_u32 s63, s61, 8192
    buffer_load_dwordx4 v11, s[8:11], s63 offen  lds
    s_add_u32 m0, s56, 35840
    s_add_u32 s63, s61, 12288
    buffer_load_dwordx4 v12, s[8:11], s63 offen  lds
    s_add_u32 m0, s57, 16384
    s_add_u32 s63, s60, s49
    buffer_load_dwordx4 v13, s[12:15], s63 offen  lds
    s_add_u32 m0, s57, 17408
    s_add_u32 s63, s60, s49
    s_add_u32 s63, s63, 8192
    buffer_load_dwordx4 v14, s[12:15], s63 offen  lds
    s_waitcnt lgkmcnt(0)
    s_barrier
    ds_read_b128 a[64:67], v1 offset:0
    ds_read_b128 a[68:71], v2 offset:0
    ds_read_b128 a[72:75], v3 offset:0
    ds_read_b128 a[76:79], v4 offset:0
    s_add_u32 s60, s101, 7
    s_and_b32 s60, s60, 7
    s_lshl_b32 s60, s60, 7
    s_add_u32 s61, s60, s48
    s_add_u32 m0, s56, 49152
    s_add_u32 s63, s61, 0
    buffer_load_dwordx4 v11, s[8:11], s63 offen  lds
    s_add_u32 m0, s56, 50176
    s_add_u32 s63, s61, 4096
    buffer_load_dwordx4 v12, s[8:11], s63 offen  lds
    s_add_u32 m0, s56, 51200
    s_add_u32 s63, s61, 8192
    buffer_load_dwordx4 v11, s[8:11], s63 offen  lds
    s_add_u32 m0, s56, 52224
    s_add_u32 s63, s61, 12288
    buffer_load_dwordx4 v12, s[8:11], s63 offen  lds
    s_add_u32 m0, s57, 24576
    s_add_u32 s63, s60, s49
    buffer_load_dwordx4 v13, s[12:15], s63 offen  lds
    s_add_u32 m0, s57, 25600
    s_add_u32 s63, s60, s49
    s_add_u32 s63, s63, 8192
    buffer_load_dwordx4 v14, s[12:15], s63 offen  lds
    s_waitcnt vmcnt(12)
    s_waitcnt lgkmcnt(0)
    s_barrier
    ds_read_b128 a[80:83], v1 offset:16384
    ds_read_b128 a[84:87], v2 offset:16384
    ds_read_b128 a[88:91], v3 offset:16384
    ds_read_b128 a[92:95], v4 offset:16384
    s_lshl_b32 s62, s44, 1
    s_add_u32 s62, s62, 2
    s_and_b32 s62, s62, 15
    s_mul_i32 s62, s62, 88064
    s_add_u32 s62, s62, s50
    s_add_u32 m0, s58, 122880
    s_nop 0
    buffer_load_dwordx4 v15, s[16:19], s62 offen  lds
    s_add_u32 m0, s58, 123904
    s_nop 0
    buffer_load_dwordx4 v16, s[16:19], s62 offen  lds
    s_add_u32 m0, s58, 124928
    s_nop 0
    buffer_load_dwordx4 v17, s[16:19], s62 offen  lds
    s_lshl_b32 s62, s44, 1
    s_add_u32 s62, s62, 3
    s_and_b32 s62, s62, 15
    s_mul_i32 s62, s62, 88064
    s_add_u32 s62, s62, s50
    s_add_u32 m0, s58, 98304
    s_nop 0
    buffer_load_dwordx4 v15, s[16:19], s62 offen  lds
    s_add_u32 m0, s58, 99328
    s_nop 0
    buffer_load_dwordx4 v16, s[16:19], s62 offen  lds
    s_add_u32 m0, s58, 100352
    s_nop 0
    buffer_load_dwordx4 v17, s[16:19], s62 offen  lds
    s_lshl_b32 s62, s44, 1
    s_add_u32 s62, s62, 4
    s_and_b32 s62, s62, 15
    s_mul_i32 s62, s62, 88064
    s_add_u32 s62, s62, s50
    s_add_u32 m0, s58, 110592
    s_nop 0
    buffer_load_dwordx4 v15, s[16:19], s62 offen  lds
    s_add_u32 m0, s58, 111616
    s_nop 0
    buffer_load_dwordx4 v16, s[16:19], s62 offen  lds
    s_add_u32 m0, s58, 112640
    s_nop 0
    buffer_load_dwordx4 v17, s[16:19], s62 offen  lds
    s_lshl_b32 s62, s44, 1
    s_add_u32 s62, s62, 5
    s_and_b32 s62, s62, 15
    s_mul_i32 s62, s62, 88064
    s_add_u32 s62, s62, s50
    s_add_u32 m0, s58, 135168
    s_nop 0
    buffer_load_dwordx4 v15, s[16:19], s62 offen  lds
    s_add_u32 m0, s58, 136192
    s_nop 0
    buffer_load_dwordx4 v16, s[16:19], s62 offen  lds
    s_add_u32 m0, s58, 137216
    s_nop 0
    buffer_load_dwordx4 v17, s[16:19], s62 offen  lds
    s_lshl_b32 s62, s44, 1
    s_add_u32 s62, s62, 6
    s_and_b32 s62, s62, 15
    s_mul_i32 s62, s62, 88064
    s_add_u32 s62, s62, s50
    s_add_u32 m0, s58, 0
    s_nop 0
    buffer_load_dwordx4 v15, s[16:19], s62 offen  lds
    s_add_u32 m0, s58, 1024
    s_nop 0
    buffer_load_dwordx4 v16, s[16:19], s62 offen  lds
    s_add_u32 m0, s58, 2048
    s_nop 0
    buffer_load_dwordx4 v17, s[16:19], s62 offen  lds
    s_waitcnt vmcnt(21)
    s_waitcnt lgkmcnt(0)
    s_barrier
    v_lshlrev_b32 v27, 4, v26
    buffer_load_dwordx4 a[0:3], v27, s[20:23], s47 offen offset:0 sc1
    buffer_load_dwordx4 a[4:7], v27, s[20:23], s47 offen offset:1024 sc1
    ds_read_b128 a[96:99], v1 offset:32768
    ds_read_b128 a[100:103], v2 offset:32768
    ds_read_b128 a[104:107], v3 offset:32768
    ds_read_b128 a[108:111], v4 offset:32768
    s_lshl_b32 s62, s44, 1
    s_add_u32 s62, s62, 7
    s_and_b32 s62, s62, 15
    s_mul_i32 s62, s62, 88064
    s_add_u32 s62, s62, s50
    s_add_u32 m0, s58, 12288
    s_nop 0
    buffer_load_dwordx4 v15, s[16:19], s62 offen  lds
    s_add_u32 m0, s58, 13312
    s_nop 0
    buffer_load_dwordx4 v16, s[16:19], s62 offen  lds
    s_add_u32 m0, s58, 14336
    s_nop 0
    buffer_load_dwordx4 v17, s[16:19], s62 offen  lds
    s_waitcnt vmcnt(20)
    s_waitcnt lgkmcnt(0)
    s_barrier
    ds_read_b128 a[112:115], v1 offset:49152
    ds_read_b128 a[116:119], v2 offset:49152
    ds_read_b128 a[120:123], v3 offset:49152
    ds_read_b128 a[124:127], v4 offset:49152
    s_lshl_b32 s62, s44, 1
    s_add_u32 s62, s62, 8
    s_and_b32 s62, s62, 15
    s_mul_i32 s62, s62, 88064
    s_add_u32 s62, s62, s50
    s_add_u32 m0, s58, 24576
    s_nop 0
    buffer_load_dwordx4 v15, s[16:19], s62 offen  lds
    s_add_u32 m0, s58, 25600
    s_nop 0
    buffer_load_dwordx4 v16, s[16:19], s62 offen  lds
    s_add_u32 m0, s58, 26624
    s_nop 0
    buffer_load_dwordx4 v17, s[16:19], s62 offen  lds
    s_lshl_b32 s62, s44, 1
    s_add_u32 s62, s62, 9
    s_and_b32 s62, s62, 15
    s_mul_i32 s62, s62, 88064
    s_add_u32 s62, s62, s50
    s_add_u32 m0, s58, 36864
    s_nop 0
    buffer_load_dwordx4 v15, s[16:19], s62 offen  lds
    s_add_u32 m0, s58, 37888
    s_nop 0
    buffer_load_dwordx4 v16, s[16:19], s62 offen  lds
    s_add_u32 m0, s58, 38912
    s_nop 0
    buffer_load_dwordx4 v17, s[16:19], s62 offen  lds
    s_waitcnt vmcnt(9)
F_GAZ:
    v_mov_b32 v31, 0
    v_accvgpr_read_b32 v32, a0
    v_accvgpr_read_b32 v33, a1
    v_accvgpr_read_b32 v34, a2
    v_accvgpr_read_b32 v35, a3
    v_accvgpr_read_b32 v36, a4
    v_accvgpr_read_b32 v37, a5
    v_accvgpr_read_b32 v38, a6
    v_accvgpr_read_b32 v39, a7
    v_xor_b32 v33, s46, v33
    v_xor_b32 v35, s46, v35
    v_xor_b32 v37, s46, v37
    v_xor_b32 v39, s46, v39
    v_or3_b32 v31, v31, v33, v35
    v_or3_b32 v31, v31, v37, v39
    v_cmp_ne_u32 vcc, 0, v31
    s_nop 1
    s_cmp_eq_u64 vcc, 0
    s_cbranch_scc1 F_GAZ_OK
    v_lshlrev_b32 v27, 4, v26
    buffer_load_dwordx4 a[0:3], v27, s[20:23], s47 offen offset:0 sc1
    buffer_load_dwordx4 a[4:7], v27, s[20:23], s47 offen offset:1024 sc1
    s_waitcnt vmcnt(0)
    s_branch F_GAZ
F_GAZ_OK:
    v_add_f32 v32, v32, v34
    v_add_f32 v36, v36, v38
    v_add_f32 v32, v32, v36
    v_and_b32 v29, v22, v32
    v_sub_f32 v32, v32, v29
    v_and_b32 v35, v22, v32
    v_lshrrev_b32 v29, 16, v29
    v_or_b32 v34, v35, v29
    v_sub_f32 v32, v32, v35
    v_lshrrev_b32 v35, 16, v32
    s_add_u32 s52, s41, 2
    s_lshl_b32 s52, s52, 9
    s_add_u32 s52, s52, 158272
    v_lshl_add_u32 v27, v26, 3, s52
    ds_write_b64 v27, v[34:35]
    s_waitcnt lgkmcnt(0)
    s_barrier
    ds_read_b64_tr_b16 v[48:49], v9 offset:36928
    ds_read_b64_tr_b16 v[50:51], v9 offset:37696
    ds_read_b64_tr_b16 v[52:53], v9 offset:43072
    ds_read_b64_tr_b16 v[54:55], v9 offset:43840
    ds_read_b64_tr_b16 v[56:57], v9 offset:36992
    ds_read_b64_tr_b16 v[58:59], v9 offset:37760
    ds_read_b64_tr_b16 v[60:61], v9 offset:43136
    ds_read_b64_tr_b16 v[62:63], v9 offset:43904
    ds_read_b64_tr_b16 v[32:33], v9 offset:40000
    ds_read_b64_tr_b16 v[34:35], v9 offset:40768
    ds_read_b64_tr_b16 v[36:37], v9 offset:46144
    ds_read_b64_tr_b16 v[38:39], v9 offset:46912
    ds_read_b64_tr_b16 v[40:41], v9 offset:40064
    ds_read_b64_tr_b16 v[42:43], v9 offset:40832
    ds_read_b64_tr_b16 v[44:45], v9 offset:46208
    ds_read_b64_tr_b16 v[46:47], v9 offset:46976
    s_lshl_b32 s62, s44, 1
    s_add_u32 s62, s62, 10
    s_and_b32 s62, s62, 15
    s_mul_i32 s62, s62, 88064
    s_add_u32 s62, s62, s50
    s_add_u32 m0, s58, 86016
    s_nop 0
    buffer_load_dwordx4 v15, s[16:19], s62 offen  lds
    s_waitcnt lgkmcnt(12)
    v_mfma_f32_32x32x16_bf16 v[64:79], v[48:51], a[16:19], v[64:79]
    v_mfma_f32_32x32x16_bf16 v[80:95], v[52:55], a[16:19], v[80:95]
    ds_read_b64_tr_b16 v[48:49], v9 offset:12352
    ds_read_b64_tr_b16 v[50:51], v9 offset:13120
    ds_read_b64_tr_b16 v[52:53], v9 offset:18496
    ds_read_b64_tr_b16 v[54:55], v9 offset:19264
    s_add_u32 m0, s58, 87040
    s_nop 0
    buffer_load_dwordx4 v16, s[16:19], s62 offen  lds
    s_waitcnt lgkmcnt(12)
    v_mfma_f32_32x32x16_bf16 v[96:111], v[56:59], a[16:19], v[96:111]
    v_mfma_f32_32x32x16_bf16 v[112:127], v[60:63], a[16:19], v[112:127]
    ds_read_b64_tr_b16 v[56:57], v9 offset:12416
    ds_read_b64_tr_b16 v[58:59], v9 offset:13184
    ds_read_b64_tr_b16 v[60:61], v9 offset:18560
    ds_read_b64_tr_b16 v[62:63], v9 offset:19328
    s_add_u32 m0, s58, 88064
    s_nop 0
    buffer_load_dwordx4 v17, s[16:19], s62 offen  lds
    s_waitcnt lgkmcnt(12)
    v_mfma_f32_32x32x16_bf16 v[64:79], v[32:35], a[20:23], v[64:79]
    v_mfma_f32_32x32x16_bf16 v[80:95], v[36:39], a[20:23], v[80:95]
    ds_read_b64_tr_b16 v[32:33], v9 offset:15424
    ds_read_b64_tr_b16 v[34:35], v9 offset:16192
    ds_read_b64_tr_b16 v[36:37], v9 offset:21568
    ds_read_b64_tr_b16 v[38:39], v9 offset:22336
    s_lshl_b32 s62, s44, 1
    s_add_u32 s62, s62, 11
    s_and_b32 s62, s62, 15
    s_mul_i32 s62, s62, 88064
    s_add_u32 s62, s62, s50
    s_add_u32 m0, s58, 49152
    s_nop 0
    buffer_load_dwordx4 v15, s[16:19], s62 offen  lds
    s_waitcnt lgkmcnt(12)
    v_mfma_f32_32x32x16_bf16 v[96:111], v[40:43], a[20:23], v[96:111]
    v_mfma_f32_32x32x16_bf16 v[112:127], v[44:47], a[20:23], v[112:127]
    ds_read_b64_tr_b16 v[40:41], v9 offset:15488
    ds_read_b64_tr_b16 v[42:43], v9 offset:16256
    ds_read_b64_tr_b16 v[44:45], v9 offset:21632
    ds_read_b64_tr_b16 v[46:47], v9 offset:22400
    s_add_u32 m0, s58, 50176
    s_nop 0
    buffer_load_dwordx4 v16, s[16:19], s62 offen  lds
    s_mul_i32 s52, s85, 43
    s_mul_i32 s53, s41, 11
    s_add_u32 s52, s52, s53
    s_mul_i32 s87, s84, 172
    s_mul_i32 s53, s41, 22
    s_add_u32 s87, s87, s53
    s_lshl_b32 s87, s87, 10
    s_lshl_b32 s86, s52, 12
    s_add_u32 s86, s86, 13631488
    s_lshl_b32 s99, s52, 2
    s_add_u32 s99, s99, 10616832
    v_lshlrev_b32 v1, 4, v26
    s_cmp_eq_u32 s41, 3
    s_cselect_b32 s52, 10, 11
    s_cselect_b32 s100, 1073741824, 0
    v_lshlrev_b32 v2, 2, v26
    v_cmp_gt_u32 vcc, s52, v26
    s_nop 1
    v_cndmask_b32 v2, 0, v2, vcc
    buffer_load_dword v3, v2, s[20:23], s99 offen sc1
    s_waitcnt lgkmcnt(12)
    v_mfma_f32_32x32x16_bf16 v[64:79], v[48:51], a[24:27], v[64:79]
    v_mfma_f32_32x32x16_bf16 v[80:95], v[52:55], a[24:27], v[80:95]
    ds_read_b64_tr_b16 v[48:49], v9 offset:24640
    ds_read_b64_tr_b16 v[50:51], v9 offset:25408
    ds_read_b64_tr_b16 v[52:53], v9 offset:30784
    ds_read_b64_tr_b16 v[54:55], v9 offset:31552
    s_add_u32 m0, s58, 51200
    s_nop 0
    buffer_load_dwordx4 v17, s[16:19], s62 offen  lds
    s_waitcnt lgkmcnt(12)
    v_mfma_f32_32x32x16_bf16 v[96:111], v[56:59], a[24:27], v[96:111]
    v_mfma_f32_32x32x16_bf16 v[112:127], v[60:63], a[24:27], v[112:127]
    ds_read_b64_tr_b16 v[56:57], v9 offset:24704
    ds_read_b64_tr_b16 v[58:59], v9 offset:25472
    ds_read_b64_tr_b16 v[60:61], v9 offset:30848
    ds_read_b64_tr_b16 v[62:63], v9 offset:31616
    s_waitcnt lgkmcnt(12)
    v_mfma_f32_32x32x16_bf16 v[64:79], v[32:35], a[28:31], v[64:79]
    v_mfma_f32_32x32x16_bf16 v[80:95], v[36:39], a[28:31], v[80:95]
    ds_read_b64_tr_b16 v[32:33], v9 offset:27712
    ds_read_b64_tr_b16 v[34:35], v9 offset:28480
    ds_read_b64_tr_b16 v[36:37], v9 offset:33856
    ds_read_b64_tr_b16 v[38:39], v9 offset:34624
    s_waitcnt lgkmcnt(12)
    v_mfma_f32_32x32x16_bf16 v[96:111], v[40:43], a[28:31], v[96:111]
    v_mfma_f32_32x32x16_bf16 v[112:127], v[44:47], a[28:31], v[112:127]
    ds_read_b64_tr_b16 v[40:41], v9 offset:27776
    ds_read_b64_tr_b16 v[42:43], v9 offset:28544
    ds_read_b64_tr_b16 v[44:45], v9 offset:33920
    ds_read_b64_tr_b16 v[46:47], v9 offset:34688
    s_waitcnt lgkmcnt(12)
    v_mfma_f32_32x32x16_bf16 v[64:79], v[48:51], a[32:35], v[64:79]
    v_mfma_f32_32x32x16_bf16 v[80:95], v[52:55], a[32:35], v[80:95]
    ds_read_b64_tr_b16 v[48:49], v9 offset:49216
    ds_read_b64_tr_b16 v[50:51], v9 offset:49984
    ds_read_b64_tr_b16 v[52:53], v9 offset:55360
    ds_read_b64_tr_b16 v[54:55], v9 offset:56128
    s_waitcnt lgkmcnt(12)
    v_mfma_f32_32x32x16_bf16 v[96:111], v[56:59], a[32:35], v[96:111]
    v_mfma_f32_32x32x16_bf16 v[112:127], v[60:63], a[32:35], v[112:127]
    ds_read_b64_tr_b16 v[56:57], v9 offset:49280
    ds_read_b64_tr_b16 v[58:59], v9 offset:50048
    ds_read_b64_tr_b16 v[60:61], v9 offset:55424
    ds_read_b64_tr_b16 v[62:63], v9 offset:56192
    s_waitcnt lgkmcnt(12)
    v_mfma_f32_32x32x16_bf16 v[64:79], v[32:35], a[36:39], v[64:79]
    v_mfma_f32_32x32x16_bf16 v[80:95], v[36:39], a[36:39], v[80:95]
    ds_read_b64_tr_b16 v[32:33], v9 offset:52288
    ds_read_b64_tr_b16 v[34:35], v9 offset:53056
    ds_read_b64_tr_b16 v[36:37], v9 offset:58432
    ds_read_b64_tr_b16 v[38:39], v9 offset:59200
    s_waitcnt lgkmcnt(12)
    v_mfma_f32_32x32x16_bf16 v[96:111], v[40:43], a[36:39], v[96:111]
    v_mfma_f32_32x32x16_bf16 v[112:127], v[44:47], a[36:39], v[112:127]
    ds_read_b64_tr_b16 v[40:41], v9 offset:52352
    ds_read_b64_tr_b16 v[42:43], v9 offset:53120
    ds_read_b64_tr_b16 v[44:45], v9 offset:58496
    ds_read_b64_tr_b16 v[46:47], v9 offset:59264
    s_waitcnt vmcnt(1)
F_RFZ:
    v_xor_b32 v31, s46, v3
    v_cmp_ne_u32 vcc, 0, v31
    s_nop 1
    s_cmp_eq_u64 vcc, 0
    s_cbranch_scc1 F_RFZ_OK
    buffer_load_dword v3, v2, s[20:23], s99 offen sc1
    s_waitcnt vmcnt(0)
    s_branch F_RFZ
F_RFZ_OK:
    s_add_u32 s52, s86, 0
    buffer_load_dwordx4 a[16:19], v1, s[20:23], s52 offen offset:0 sc1
    s_waitcnt lgkmcnt(12)
    v_mfma_f32_32x32x16_bf16 v[64:79], v[48:51], a[40:43], v[64:79]
    v_mfma_f32_32x32x16_bf16 v[80:95], v[52:55], a[40:43], v[80:95]
    ds_read_b64_tr_b16 v[48:49], v10 offset:64
    ds_read_b64_tr_b16 v[50:51], v10 offset:832
    ds_read_b64_tr_b16 v[52:53], v10 offset:6208
    ds_read_b64_tr_b16 v[54:55], v10 offset:6976
    s_add_u32 s52, s86, 0
    buffer_load_dwordx4 a[20:23], v1, s[20:23], s52 offen offset:1024 sc1
    s_waitcnt lgkmcnt(12)
    v_mfma_f32_32x32x16_bf16 v[96:111], v[56:59], a[40:43], v[96:111]
    v_mfma_f32_32x32x16_bf16 v[112:127], v[60:63], a[40:43], v[112:127]
    ds_read_b64_tr_b16 v[56:57], v10 offset:128
    ds_read_b64_tr_b16 v[58:59], v10 offset:896
    ds_read_b64_tr_b16 v[60:61], v10 offset:6272
    ds_read_b64_tr_b16 v[62:63], v10 offset:7040
    s_add_u32 s52, s86, 0
    buffer_load_dwordx4 a[24:27], v1, s[20:23], s52 offen offset:2048 sc1
    s_waitcnt lgkmcnt(12)
    v_mfma_f32_32x32x16_bf16 v[64:79], v[32:35], a[44:47], v[64:79]
    v_mfma_f32_32x32x16_bf16 v[80:95], v[36:39], a[44:47], v[80:95]
    ds_read_b64_tr_b16 v[32:33], v10 offset:3136
    ds_read_b64_tr_b16 v[34:35], v10 offset:3904
    ds_read_b64_tr_b16 v[36:37], v10 offset:9280
    ds_read_b64_tr_b16 v[38:39], v10 offset:10048
    s_add_u32 s52, s86, 0
    buffer_load_dwordx4 a[28:31], v1, s[20:23], s52 offen offset:3072 sc1
    s_waitcnt lgkmcnt(12)
    v_mfma_f32_32x32x16_bf16 v[96:111], v[40:43], a[44:47], v[96:111]
    v_mfma_f32_32x32x16_bf16 v[112:127], v[44:47], a[44:47], v[112:127]
    ds_read_b64_tr_b16 v[40:41], v10 offset:3200
    ds_read_b64_tr_b16 v[42:43], v10 offset:3968
    ds_read_b64_tr_b16 v[44:45], v10 offset:9344
    ds_read_b64_tr_b16 v[46:47], v10 offset:10112
    s_add_u32 s52, s86, 4096
    buffer_load_dwordx4 a[32:35], v1, s[20:23], s52 offen offset:0 sc1
    s_waitcnt lgkmcnt(12)
    v_mfma_f32_32x32x16_bf16 v[64:79], v[48:51], a[48:51], v[64:79]
    v_mfma_f32_32x32x16_bf16 v[80:95], v[52:55], a[48:51], v[80:95]
    s_add_u32 s52, s86, 4096
    buffer_load_dwordx4 a[36:39], v1, s[20:23], s52 offen offset:1024 sc1
    s_waitcnt lgkmcnt(8)
    v_mfma_f32_32x32x16_bf16 v[96:111], v[56:59], a[48:51], v[96:111]
    v_mfma_f32_32x32x16_bf16 v[112:127], v[60:63], a[48:51], v[112:127]
    s_waitcnt vmcnt(6)
    s_waitcnt lgkmcnt(0)
    s_barrier
    ds_read_b64_tr_b16 v[48:49], v10 offset:12352
    ds_read_b64_tr_b16 v[50:51], v10 offset:13120
    ds_read_b64_tr_b16 v[52:53], v10 offset:18496
    ds_read_b64_tr_b16 v[54:55], v10 offset:19264
    ds_read_b64_tr_b16 v[56:57], v10 offset:12416
    ds_read_b64_tr_b16 v[58:59], v10 offset:13184
    ds_read_b64_tr_b16 v[60:61], v10 offset:18560
    ds_read_b64_tr_b16 v[62:63], v10 offset:19328
    s_lshl_b32 s62, s44, 1
    s_add_u32 s62, s62, 12
    s_and_b32 s62, s62, 15
    s_mul_i32 s62, s62, 88064
    s_add_u32 s62, s62, s50
    s_add_u32 m0, s58, 98304
    s_nop 0
    buffer_load_dwordx4 v15, s[16:19], s62 offen  lds
    s_add_u32 m0, s58, 99328
    s_nop 0
    buffer_load_dwordx4 v16, s[16:19], s62 offen  lds
    v_mfma_f32_32x32x16_bf16 v[64:79], v[32:35], a[52:55], v[64:79]
    v_mfma_f32_32x32x16_bf16 v[80:95], v[36:39], a[52:55], v[80:95]
    ds_read_b64_tr_b16 v[32:33], v10 offset:15424
    ds_read_b64_tr_b16 v[34:35], v10 offset:16192
    ds_read_b64_tr_b16 v[36:37], v10 offset:21568
    ds_read_b64_tr_b16 v[38:39], v10 offset:22336
    s_add_u32 m0, s58, 100352
    s_nop 0
    buffer_load_dwordx4 v17, s[16:19], s62 offen  lds
    s_lshl_b32 s62, s44, 1
    s_add_u32 s62, s62, 13
    s_and_b32 s62, s62, 15
    s_mul_i32 s62, s62, 88064
    s_add_u32 s62, s62, s50
    s_add_u32 m0, s58, 110592
    s_nop 0
    buffer_load_dwordx4 v15, s[16:19], s62 offen  lds
    v_mfma_f32_32x32x16_bf16 v[96:111], v[40:43], a[52:55], v[96:111]
    v_mfma_f32_32x32x16_bf16 v[112:127], v[44:47], a[52:55], v[112:127]
    ds_read_b64_tr_b16 v[40:41], v10 offset:15488
    ds_read_b64_tr_b16 v[42:43], v10 offset:16256
    ds_read_b64_tr_b16 v[44:45], v10 offset:21632
    ds_read_b64_tr_b16 v[46:47], v10 offset:22400
    s_add_u32 m0, s58, 111616
    s_nop 0
    buffer_load_dwordx4 v16, s[16:19], s62 offen  lds
    s_waitcnt lgkmcnt(12)
    v_mfma_f32_32x32x16_bf16 v[64:79], v[48:51], a[56:59], v[64:79]
    v_mfma_f32_32x32x16_bf16 v[80:95], v[52:55], a[56:59], v[80:95]
    ds_read_b64_tr_b16 v[48:49], v10 offset:24640
    ds_read_b64_tr_b16 v[50:51], v10 offset:25408
    ds_read_b64_tr_b16 v[52:53], v10 offset:30784
    ds_read_b64_tr_b16 v[54:55], v10 offset:31552
    s_add_u32 m0, s58, 112640
    s_nop 0
    buffer_load_dwordx4 v17, s[16:19], s62 offen  lds
    s_waitcnt lgkmcnt(12)
    v_mfma_f32_32x32x16_bf16 v[96:111], v[56:59], a[56:59], v[96:111]
    v_mfma_f32_32x32x16_bf16 v[112:127], v[60:63], a[56:59], v[112:127]
    ds_read_b64_tr_b16 v[56:57], v10 offset:24704
    ds_read_b64_tr_b16 v[58:59], v10 offset:25472
    ds_read_b64_tr_b16 v[60:61], v10 offset:30848
    ds_read_b64_tr_b16 v[62:63], v10 offset:31616
    s_lshl_b32 s62, s44, 1
    s_add_u32 s62, s62, 14
    s_and_b32 s62, s62, 15
    s_mul_i32 s62, s62, 88064
    s_add_u32 s62, s62, s50
    s_add_u32 m0, s58, 122880
    s_nop 0
    buffer_load_dwordx4 v15, s[16:19], s62 offen  lds
    s_waitcnt lgkmcnt(12)
    v_mfma_f32_32x32x16_bf16 v[64:79], v[32:35], a[60:63], v[64:79]
    v_mfma_f32_32x32x16_bf16 v[80:95], v[36:39], a[60:63], v[80:95]
    ds_read_b64_tr_b16 v[32:33], v10 offset:27712
    ds_read_b64_tr_b16 v[34:35], v10 offset:28480
    ds_read_b64_tr_b16 v[36:37], v10 offset:33856
    ds_read_b64_tr_b16 v[38:39], v10 offset:34624
    s_add_u32 m0, s58, 123904
    s_nop 0
    buffer_load_dwordx4 v16, s[16:19], s62 offen  lds
    s_waitcnt lgkmcnt(12)
    v_mfma_f32_32x32x16_bf16 v[96:111], v[40:43], a[60:63], v[96:111]
    v_mfma_f32_32x32x16_bf16 v[112:127], v[44:47], a[60:63], v[112:127]
    ds_read_b64_tr_b16 v[40:41], v10 offset:27776
    ds_read_b64_tr_b16 v[42:43], v10 offset:28544
    ds_read_b64_tr_b16 v[44:45], v10 offset:33920
    ds_read_b64_tr_b16 v[46:47], v10 offset:34688
    s_add_u32 m0, s58, 124928
    s_nop 0
    buffer_load_dwordx4 v17, s[16:19], s62 offen  lds
    s_waitcnt lgkmcnt(12)
    v_mfma_f32_32x32x16_bf16 v[64:79], v[48:51], a[64:67], v[64:79]
    v_mfma_f32_32x32x16_bf16 v[80:95], v[52:55], a[64:67], v[80:95]
    ds_read_b64_tr_b16 v[48:49], v10 offset:36928
    ds_read_b64_tr_b16 v[50:51], v10 offset:37696
    ds_read_b64_tr_b16 v[52:53], v10 offset:43072
    ds_read_b64_tr_b16 v[54:55], v10 offset:43840
    s_lshl_b32 s62, s44, 1
    s_add_u32 s62, s62, 15
    s_and_b32 s62, s62, 15
    s_mul_i32 s62, s62, 88064
    s_add_u32 s62, s62, s50
    s_add_u32 m0, s58, 135168
    s_nop 0
    buffer_load_dwordx4 v15, s[16:19], s62 offen  lds
    s_waitcnt lgkmcnt(12)
    v_mfma_f32_32x32x16_bf16 v[96:111], v[56:59], a[64:67], v[96:111]
    v_mfma_f32_32x32x16_bf16 v[112:127], v[60:63], a[64:67], v[112:127]
    ds_read_b64_tr_b16 v[56:57], v10 offset:36992
    ds_read_b64_tr_b16 v[58:59], v10 offset:37760
    ds_read_b64_tr_b16 v[60:61], v10 offset:43136
    ds_read_b64_tr_b16 v[62:63], v10 offset:43904
    s_add_u32 m0, s58, 136192
    s_nop 0
    buffer_load_dwordx4 v16, s[16:19], s62 offen  lds
    s_waitcnt lgkmcnt(12)
    v_mfma_f32_32x32x16_bf16 v[64:79], v[32:35], a[68:71], v[64:79]
    v_mfma_f32_32x32x16_bf16 v[80:95], v[36:39], a[68:71], v[80:95]
    ds_read_b64_tr_b16 v[32:33], v10 offset:40000
    ds_read_b64_tr_b16 v[34:35], v10 offset:40768
    ds_read_b64_tr_b16 v[36:37], v10 offset:46144
    ds_read_b64_tr_b16 v[38:39], v10 offset:46912
    s_add_u32 m0, s58, 137216
    s_nop 0
    buffer_load_dwordx4 v17, s[16:19], s62 offen  lds
    s_add_u32 s52, s86, 4096
    buffer_load_dwordx4 a[40:43], v1, s[20:23], s52 offen offset:2048 sc1
    s_waitcnt lgkmcnt(12)
    v_mfma_f32_32x32x16_bf16 v[96:111], v[40:43], a[68:71], v[96:111]
    v_mfma_f32_32x32x16_bf16 v[112:127], v[44:47], a[68:71], v[112:127]
    ds_read_b64_tr_b16 v[40:41], v10 offset:40064
    ds_read_b64_tr_b16 v[42:43], v10 offset:40832
    ds_read_b64_tr_b16 v[44:45], v10 offset:46208
    ds_read_b64_tr_b16 v[46:47], v10 offset:46976
    s_add_u32 s52, s86, 4096
    buffer_load_dwordx4 a[44:47], v1, s[20:23], s52 offen offset:3072 sc1
    s_waitcnt lgkmcnt(12)
    v_mfma_f32_32x32x16_bf16 v[64:79], v[48:51], a[72:75], v[64:79]
    v_mfma_f32_32x32x16_bf16 v[80:95], v[52:55], a[72:75], v[80:95]
    ds_read_b64_tr_b16 v[48:49], v9 offset:64
    ds_read_b64_tr_b16 v[50:51], v9 offset:832
    ds_read_b64_tr_b16 v[52:53], v9 offset:6208
    ds_read_b64_tr_b16 v[54:55], v9 offset:6976
    s_add_u32 s52, s86, 8192
    buffer_load_dwordx4 a[48:51], v1, s[20:23], s52 offen offset:0 sc1
    s_waitcnt lgkmcnt(12)
    v_mfma_f32_32x32x16_bf16 v[96:111], v[56:59], a[72:75], v[96:111]
    v_mfma_f32_32x32x16_bf16 v[112:127], v[60:63], a[72:75], v[112:127]
    ds_read_b64_tr_b16 v[56:57], v9 offset:128
    ds_read_b64_tr_b16 v[58:59], v9 offset:896
    ds_read_b64_tr_b16 v[60:61], v9 offset:6272
    ds_read_b64_tr_b16 v[62:63], v9 offset:7040
    s_add_u32 s52, s86, 8192
    buffer_load_dwordx4 a[52:55], v1, s[20:23], s52 offen offset:1024 sc1
    s_waitcnt lgkmcnt(12)
    v_mfma_f32_32x32x16_bf16 v[64:79], v[32:35], a[76:79], v[64:79]
    v_mfma_f32_32x32x16_bf16 v[80:95], v[36:39], a[76:79], v[80:95]
    ds_read_b64_tr_b16 v[32:33], v9 offset:3136
    ds_read_b64_tr_b16 v[34:35], v9 offset:3904
    ds_read_b64_tr_b16 v[36:37], v9 offset:9280
    ds_read_b64_tr_b16 v[38:39], v9 offset:10048
    s_add_u32 s52, s86, 8192
    buffer_load_dwordx4 a[56:59], v1, s[20:23], s52 offen offset:2048 sc1
    s_waitcnt lgkmcnt(12)
    v_mfma_f32_32x32x16_bf16 v[96:111], v[40:43], a[76:79], v[96:111]
    v_mfma_f32_32x32x16_bf16 v[112:127], v[44:47], a[76:79], v[112:127]
    ds_read_b64_tr_b16 v[40:41], v9 offset:3200
    ds_read_b64_tr_b16 v[42:43], v9 offset:3968
    ds_read_b64_tr_b16 v[44:45], v9 offset:9344
    ds_read_b64_tr_b16 v[46:47], v9 offset:10112
    s_add_u32 s52, s86, 8192
    buffer_load_dwordx4 a[60:63], v1, s[20:23], s52 offen offset:3072 sc1
    s_waitcnt lgkmcnt(12)
    v_mfma_f32_32x32x16_bf16 v[64:79], v[48:51], a[80:83], v[64:79]
    v_mfma_f32_32x32x16_bf16 v[80:95], v[52:55], a[80:83], v[80:95]
    ds_read_b64_tr_b16 v[48:49], v10 offset:49216
    ds_read_b64_tr_b16 v[50:51], v10 offset:49984
    ds_read_b64_tr_b16 v[52:53], v10 offset:55360
    ds_read_b64_tr_b16 v[54:55], v10 offset:56128
    s_add_u32 s52, s86, 12288
    buffer_load_dwordx4 a[64:67], v1, s[20:23], s52 offen offset:0 sc1
    s_waitcnt lgkmcnt(12)
    v_mfma_f32_32x32x16_bf16 v[96:111], v[56:59], a[80:83], v[96:111]
    v_mfma_f32_32x32x16_bf16 v[112:127], v[60:63], a[80:83], v[112:127]
    ds_read_b64_tr_b16 v[56:57], v10 offset:49280
    ds_read_b64_tr_b16 v[58:59], v10 offset:50048
    ds_read_b64_tr_b16 v[60:61], v10 offset:55424
    ds_read_b64_tr_b16 v[62:63], v10 offset:56192
    s_add_u32 s52, s86, 12288
    buffer_load_dwordx4 a[68:71], v1, s[20:23], s52 offen offset:1024 sc1
    s_waitcnt lgkmcnt(12)
    v_mfma_f32_32x32x16_bf16 v[64:79], v[32:35], a[84:87], v[64:79]
    v_mfma_f32_32x32x16_bf16 v[80:95], v[36:39], a[84:87], v[80:95]
    ds_read_b64_tr_b16 v[32:33], v10 offset:52288
    ds_read_b64_tr_b16 v[34:35], v10 offset:53056
    ds_read_b64_tr_b16 v[36:37], v10 offset:58432
    ds_read_b64_tr_b16 v[38:39], v10 offset:59200
    s_add_u32 s52, s86, 12288
    buffer_load_dwordx4 a[72:75], v1, s[20:23], s52 offen offset:2048 sc1
    s_waitcnt lgkmcnt(12)
    v_mfma_f32_32x32x16_bf16 v[96:111], v[40:43], a[84:87], v[96:111]
    v_mfma_f32_32x32x16_bf16 v[112:127], v[44:47], a[84:87], v[112:127]
    ds_read_b64_tr_b16 v[40:41], v10 offset:52352
    ds_read_b64_tr_b16 v[42:43], v10 offset:53120
    ds_read_b64_tr_b16 v[44:45], v10 offset:58496
    ds_read_b64_tr_b16 v[46:47], v10 offset:59264
    s_add_u32 s52, s86, 12288
    buffer_load_dwordx4 a[76:79], v1, s[20:23], s52 offen offset:3072 sc1
    s_waitcnt lgkmcnt(12)
    v_mfma_f32_32x32x16_bf16 v[64:79], v[48:51], a[88:91], v[64:79]
    v_mfma_f32_32x32x16_bf16 v[80:95], v[52:55], a[88:91], v[80:95]
    s_waitcnt lgkmcnt(8)
    v_mfma_f32_32x32x16_bf16 v[96:111], v[56:59], a[88:91], v[96:111]
    v_mfma_f32_32x32x16_bf16 v[112:127], v[60:63], a[88:91], v[112:127]
    s_waitcnt vmcnt(10)
    s_waitcnt lgkmcnt(0)
    s_barrier
    ds_read_b64_tr_b16 v[48:49], v9 offset:12352
    ds_read_b64_tr_b16 v[50:51], v9 offset:13120
    ds_read_b64_tr_b16 v[52:53], v9 offset:18496
    ds_read_b64_tr_b16 v[54:55], v9 offset:19264
    ds_read_b64_tr_b16 v[56:57], v9 offset:12416
    ds_read_b64_tr_b16 v[58:59], v9 offset:13184
    ds_read_b64_tr_b16 v[60:61], v9 offset:18560
    ds_read_b64_tr_b16 v[62:63], v9 offset:19328
    v_mfma_f32_32x32x16_bf16 v[64:79], v[32:35], a[92:95], v[64:79]
    v_mfma_f32_32x32x16_bf16 v[80:95], v[36:39], a[92:95], v[80:95]
    ds_read_b64_tr_b16 v[32:33], v9 offset:15424
    ds_read_b64_tr_b16 v[34:35], v9 offset:16192
    ds_read_b64_tr_b16 v[36:37], v9 offset:21568
    ds_read_b64_tr_b16 v[38:39], v9 offset:22336
    v_mfma_f32_32x32x16_bf16 v[96:111], v[40:43], a[92:95], v[96:111]
    v_mfma_f32_32x32x16_bf16 v[112:127], v[44:47], a[92:95], v[112:127]
    ds_read_b64_tr_b16 v[40:41], v9 offset:15488
    ds_read_b64_tr_b16 v[42:43], v9 offset:16256
    ds_read_b64_tr_b16 v[44:45], v9 offset:21632
    ds_read_b64_tr_b16 v[46:47], v9 offset:22400
    s_add_u32 s52, s86, 16384
    buffer_load_dwordx4 a[80:83], v1, s[20:23], s52 offen offset:0 sc1
    s_waitcnt lgkmcnt(12)
    v_mfma_f32_32x32x16_bf16 v[64:79], v[48:51], a[96:99], v[64:79]
    v_mfma_f32_32x32x16_bf16 v[80:95], v[52:55], a[96:99], v[80:95]
    ds_read_b64_tr_b16 v[48:49], v9 offset:24640
    ds_read_b64_tr_b16 v[50:51], v9 offset:25408
    ds_read_b64_tr_b16 v[52:53], v9 offset:30784
    ds_read_b64_tr_b16 v[54:55], v9 offset:31552
    s_add_u32 s52, s86, 16384
    buffer_load_dwordx4 a[84:87], v1, s[20:23], s52 offen offset:1024 sc1
    s_waitcnt lgkmcnt(12)
    v_mfma_f32_32x32x16_bf16 v[96:111], v[56:59], a[96:99], v[96:111]
    v_mfma_f32_32x32x16_bf16 v[112:127], v[60:63], a[96:99], v[112:127]
    ds_read_b64_tr_b16 v[56:57], v9 offset:24704
    ds_read_b64_tr_b16 v[58:59], v9 offset:25472
    ds_read_b64_tr_b16 v[60:61], v9 offset:30848
    ds_read_b64_tr_b16 v[62:63], v9 offset:31616
    s_add_u32 s52, s86, 16384
    buffer_load_dwordx4 a[88:91], v1, s[20:23], s52 offen offset:2048 sc1
    s_waitcnt lgkmcnt(12)
    v_mfma_f32_32x32x16_bf16 v[64:79], v[32:35], a[100:103], v[64:79]
    v_mfma_f32_32x32x16_bf16 v[80:95], v[36:39], a[100:103], v[80:95]
    ds_read_b64_tr_b16 v[32:33], v9 offset:27712
    ds_read_b64_tr_b16 v[34:35], v9 offset:28480
    ds_read_b64_tr_b16 v[36:37], v9 offset:33856
    ds_read_b64_tr_b16 v[38:39], v9 offset:34624
    s_add_u32 s52, s86, 16384
    buffer_load_dwordx4 a[92:95], v1, s[20:23], s52 offen offset:3072 sc1
    s_waitcnt lgkmcnt(12)
    v_mfma_f32_32x32x16_bf16 v[96:111], v[40:43], a[100:103], v[96:111]
    v_mfma_f32_32x32x16_bf16 v[112:127], v[44:47], a[100:103], v[112:127]
    ds_read_b64_tr_b16 v[40:41], v9 offset:27776
    ds_read_b64_tr_b16 v[42:43], v9 offset:28544
    ds_read_b64_tr_b16 v[44:45], v9 offset:33920
    ds_read_b64_tr_b16 v[46:47], v9 offset:34688
    s_waitcnt lgkmcnt(12)
    v_mfma_f32_32x32x16_bf16 v[64:79], v[48:51], a[104:107], v[64:79]
    v_mfma_f32_32x32x16_bf16 v[80:95], v[52:55], a[104:107], v[80:95]
    ds_read_b64_tr_b16 v[48:49], v9 offset:36928
    ds_read_b64_tr_b16 v[50:51], v9 offset:37696
    ds_read_b64_tr_b16 v[52:53], v9 offset:43072
    ds_read_b64_tr_b16 v[54:55], v9 offset:43840
    s_waitcnt lgkmcnt(12)
    v_mfma_f32_32x32x16_bf16 v[96:111], v[56:59], a[104:107], v[96:111]
    v_mfma_f32_32x32x16_bf16 v[112:127], v[60:63], a[104:107], v[112:127]
    ds_read_b64_tr_b16 v[56:57], v9 offset:36992
    ds_read_b64_tr_b16 v[58:59], v9 offset:37760
    ds_read_b64_tr_b16 v[60:61], v9 offset:43136
    ds_read_b64_tr_b16 v[62:63], v9 offset:43904
    s_waitcnt lgkmcnt(12)
    v_mfma_f32_32x32x16_bf16 v[64:79], v[32:35], a[108:111], v[64:79]
    v_mfma_f32_32x32x16_bf16 v[80:95], v[36:39], a[108:111], v[80:95]
    ds_read_b64_tr_b16 v[32:33], v9 offset:40000
    ds_read_b64_tr_b16 v[34:35], v9 offset:40768
    ds_read_b64_tr_b16 v[36:37], v9 offset:46144
    ds_read_b64_tr_b16 v[38:39], v9 offset:46912
    s_waitcnt lgkmcnt(12)
    v_mfma_f32_32x32x16_bf16 v[96:111], v[40:43], a[108:111], v[96:111]
    v_mfma_f32_32x32x16_bf16 v[112:127], v[44:47], a[108:111], v[112:127]
    ds_read_b64_tr_b16 v[40:41], v9 offset:40064
    ds_read_b64_tr_b16 v[42:43], v9 offset:40832
    ds_read_b64_tr_b16 v[44:45], v9 offset:46208
    ds_read_b64_tr_b16 v[46:47], v9 offset:46976
    s_add_u32 s52, s86, 20480
    buffer_load_dwordx4 a[96:99], v1, s[20:23], s52 offen offset:0 sc1
    s_waitcnt lgkmcnt(12)
    v_mfma_f32_32x32x16_bf16 v[64:79], v[48:51], a[112:115], v[64:79]
    v_mfma_f32_32x32x16_bf16 v[80:95], v[52:55], a[112:115], v[80:95]
    ds_read_b64_tr_b16 v[48:49], v9 offset:49216
    ds_read_b64_tr_b16 v[50:51], v9 offset:49984
    ds_read_b64_tr_b16 v[52:53], v9 offset:55360
    ds_read_b64_tr_b16 v[54:55], v9 offset:56128
    s_add_u32 s52, s86, 20480
    buffer_load_dwordx4 a[100:103], v1, s[20:23], s52 offen offset:1024 sc1
    s_waitcnt lgkmcnt(12)
    v_mfma_f32_32x32x16_bf16 v[96:111], v[56:59], a[112:115], v[96:111]
    v_mfma_f32_32x32x16_bf16 v[112:127], v[60:63], a[112:115], v[112:127]
    ds_read_b64_tr_b16 v[56:57], v9 offset:49280
    ds_read_b64_tr_b16 v[58:59], v9 offset:50048
    ds_read_b64_tr_b16 v[60:61], v9 offset:55424
    ds_read_b64_tr_b16 v[62:63], v9 offset:56192
    s_add_u32 s52, s86, 20480
    buffer_load_dwordx4 a[104:107], v1, s[20:23], s52 offen offset:2048 sc1
    s_waitcnt lgkmcnt(12)
    v_mfma_f32_32x32x16_bf16 v[64:79], v[32:35], a[116:119], v[64:79]
    v_mfma_f32_32x32x16_bf16 v[80:95], v[36:39], a[116:119], v[80:95]
    ds_read_b64_tr_b16 v[32:33], v9 offset:52288
    ds_read_b64_tr_b16 v[34:35], v9 offset:53056
    ds_read_b64_tr_b16 v[36:37], v9 offset:58432
    ds_read_b64_tr_b16 v[38:39], v9 offset:59200
    s_add_u32 s52, s86, 20480
    buffer_load_dwordx4 a[108:111], v1, s[20:23], s52 offen offset:3072 sc1
    s_waitcnt lgkmcnt(12)
    v_mfma_f32_32x32x16_bf16 v[96:111], v[40:43], a[116:119], v[96:111]
    v_mfma_f32_32x32x16_bf16 v[112:127], v[44:47], a[116:119], v[112:127]
    ds_read_b64_tr_b16 v[40:41], v9 offset:52352
    ds_read_b64_tr_b16 v[42:43], v9 offset:53120
    ds_read_b64_tr_b16 v[44:45], v9 offset:58496
    ds_read_b64_tr_b16 v[46:47], v9 offset:59264
    s_waitcnt lgkmcnt(12)
    v_mfma_f32_32x32x16_bf16 v[64:79], v[48:51], a[120:123], v[64:79]
    v_mfma_f32_32x32x16_bf16 v[80:95], v[52:55], a[120:123], v[80:95]
    s_waitcnt lgkmcnt(8)
    v_mfma_f32_32x32x16_bf16 v[96:111], v[56:59], a[120:123], v[96:111]
    v_mfma_f32_32x32x16_bf16 v[112:127], v[60:63], a[120:123], v[112:127]
    s_waitcnt lgkmcnt(4)
    v_mfma_f32_32x32x16_bf16 v[64:79], v[32:35], a[124:127], v[64:79]
    v_mfma_f32_32x32x16_bf16 v[80:95], v[36:39], a[124:127], v[80:95]
    s_waitcnt lgkmcnt(0)
    v_mfma_f32_32x32x16_bf16 v[96:111], v[40:43], a[124:127], v[96:111]
    v_mfma_f32_32x32x16_bf16 v[112:127], v[44:47], a[124:127], v[112:127]
    v_lshlrev_b32 v28, 3, v26
    v_add_u32 v28, 158272, v28
    ds_read_b64 v[32:33], v28 offset:1024
    ds_read_b64 v[36:37], v28 offset:1536
    ds_read_b64 v[40:41], v28 offset:2048
    ds_read_b64 v[44:45], v28 offset:2560
    v_and_b32 v27, 31, v26
    s_lshl_b32 s54, s41, 8
    s_add_u32 s54, s54, 157248
    v_lshl_add_u32 v27, v27, 3, s54
    ds_read_b64 v[18:19], v27
    v_mov_b32 v34, 0
    v_mov_b32 v35, 0
    v_mov_b32 v38, 0
    v_mov_b32 v39, 0
    v_mov_b32 v42, 0
    v_mov_b32 v43, 0
    v_mov_b32 v46, 0
    v_mov_b32 v47, 0
    s_lshl_b32 s54, s42, 2
    s_add_u32 s54, s54, s41
    s_mul_i32 s55, s54, 86
    s_lshl_b32 s54, s45, 1
    s_add_u32 s55, s55, s54
    s_lshl_b32 s55, s55, 10
    s_waitcnt lgkmcnt(0)
    v_xor_b32 v49, 0x80000000, v18
    v_lshrrev_b32 v49, 16, v49
    v_lshl_or_b32 v48, v49, 16, v49
    v_mov_b32 v50, 0
    v_mov_b32 v51, 0
    s_nop 1
    v_mfma_f32_32x32x16_bf16 v[64:79], v[32:35], v[48:51], v[64:79]
    s_nop 0
    v_mfma_f32_32x32x16_bf16 v[80:95], v[36:39], v[48:51], v[80:95]
    v_mfma_f32_32x32x16_bf16 v[96:111], v[40:43], v[48:51], v[96:111]
    v_mfma_f32_32x32x16_bf16 v[112:127], v[44:47], v[48:51], v[112:127]
    v_mul_f32 v20, v19, v19
    v_lshlrev_b32 v28, 4, v26
    s_nop 6
    v_max_f32 v64, 0, v64
    s_nop 5
    v_max_f32 v65, 0, v65
    s_nop 4
    v_max_f32 v66, 0, v66
    s_nop 3
    v_max_f32 v67, 0, v67
    s_nop 2
    v_max_f32 v68, 0, v68
    s_nop 1
    v_max_f32 v69, 0, v69
    s_nop 0
    v_max_f32 v70, 0, v70
    v_max_f32 v71, 0, v71
    v_max_f32 v72, 0, v72
    v_max_f32 v73, 0, v73
    v_max_f32 v74, 0, v74
    v_max_f32 v75, 0, v75
    v_max_f32 v76, 0, v76
    v_max_f32 v77, 0, v77
    v_max_f32 v78, 0, v78
    v_max_f32 v79, 0, v79
    v_mul_f32 v80, v20, v80
    v_mul_f32 v81, v20, v81
    v_mul_f32 v82, v20, v82
    v_mul_f32 v83, v20, v83
    v_mul_f32 v84, v20, v84
    v_mul_f32 v85, v20, v85
    v_mul_f32 v86, v20, v86
    v_mul_f32 v87, v20, v87
    v_mul_f32 v88, v20, v88
    v_mul_f32 v89, v20, v89
    v_mul_f32 v90, v20, v90
    v_mul_f32 v91, v20, v91
    v_mul_f32 v92, v20, v92
    v_mul_f32 v93, v20, v93
    v_mul_f32 v94, v20, v94
    v_mul_f32 v95, v20, v95
    v_mul_f32 v64, v64, v80
    v_mul_f32 v65, v65, v81
    v_mul_f32 v66, v66, v82
    v_mul_f32 v67, v67, v83
    v_mul_f32 v68, v68, v84
    v_mul_f32 v69, v69, v85
    v_mul_f32 v70, v70, v86
    v_mul_f32 v71, v71, v87
    v_mul_f32 v72, v72, v88
    v_mul_f32 v73, v73, v89
    v_mul_f32 v74, v74, v90
    v_mul_f32 v75, v75, v91
    v_mul_f32 v76, v76, v92
    v_mul_f32 v77, v77, v93
    v_mul_f32 v78, v78, v94
    v_mul_f32 v79, v79, v95
    v_cvt_pk_bf16_f32 v80, v64, v65
    v_cvt_pk_bf16_f32 v81, v66, v67
    v_cvt_pk_bf16_f32 v82, v68, v69
    v_cvt_pk_bf16_f32 v83, v70, v71
    v_cvt_pk_bf16_f32 v84, v72, v73
    v_cvt_pk_bf16_f32 v85, v74, v75
    v_cvt_pk_bf16_f32 v86, v76, v77
    v_cvt_pk_bf16_f32 v87, v78, v79
    s_add_u32 s54, s55, 2048
    buffer_store_dwordx4 v[80:83], v28, s[20:23], s54 offen offset:0 sc1
    buffer_store_dwordx4 v[84:87], v28, s[20:23], s54 offen offset:1024 sc1
    v_max_f32 v96, 0, v96
    v_max_f32 v97, 0, v97
    v_max_f32 v98, 0, v98
    v_max_f32 v99, 0, v99
    v_max_f32 v100, 0, v100
    v_max_f32 v101, 0, v101
    v_max_f32 v102, 0, v102
    v_max_f32 v103, 0, v103
    v_max_f32 v104, 0, v104
    v_max_f32 v105, 0, v105
    v_max_f32 v106, 0, v106
    v_max_f32 v107, 0, v107
    v_max_f32 v108, 0, v108
    v_max_f32 v109, 0, v109
    v_max_f32 v110, 0, v110
    v_max_f32 v111, 0, v111
    v_mul_f32 v112, v20, v112
    v_mul_f32 v113, v20, v113
    v_mul_f32 v114, v20, v114
    v_mul_f32 v115, v20, v115
    v_mul_f32 v116, v20, v116
    v_mul_f32 v117, v20, v117
    v_mul_f32 v118, v20, v118
    v_mul_f32 v119, v20, v119
    v_mul_f32 v120, v20, v120
    v_mul_f32 v121, v20, v121
    v_mul_f32 v122, v20, v122
    v_mul_f32 v123, v20, v123
    v_mul_f32 v124, v20, v124
    v_mul_f32 v125, v20, v125
    v_mul_f32 v126, v20, v126
    v_mul_f32 v127, v20, v127
    v_mul_f32 v96, v96, v112
    v_mul_f32 v97, v97, v113
    v_mul_f32 v98, v98, v114
    v_mul_f32 v99, v99, v115
    v_mul_f32 v100, v100, v116
    v_mul_f32 v101, v101, v117
    v_mul_f32 v102, v102, v118
    v_mul_f32 v103, v103, v119
    v_mul_f32 v104, v104, v120
    v_mul_f32 v105, v105, v121
    v_mul_f32 v106, v106, v122
    v_mul_f32 v107, v107, v123
    v_mul_f32 v108, v108, v124
    v_mul_f32 v109, v109, v125
    v_mul_f32 v110, v110, v126
    v_mul_f32 v111, v111, v127
    v_cvt_pk_bf16_f32 v112, v96, v97
    v_cvt_pk_bf16_f32 v113, v98, v99
    v_cvt_pk_bf16_f32 v114, v100, v101
    v_cvt_pk_bf16_f32 v115, v102, v103
    v_cvt_pk_bf16_f32 v116, v104, v105
    v_cvt_pk_bf16_f32 v117, v106, v107
    v_cvt_pk_bf16_f32 v118, v108, v109
    v_cvt_pk_bf16_f32 v119, v110, v111
    s_add_u32 s54, s55, 4096
    s_add_u32 s54, s54, s51
    buffer_store_dwordx4 v[112:115], v28, s[20:23], s54 offen offset:0 sc1
    buffer_store_dwordx4 v[116:119], v28, s[20:23], s54 offen offset:1024 sc1
    s_add_u32 s52, s86, 24576
    buffer_load_dwordx4 a[112:115], v1, s[20:23], s52 offen offset:0 sc1
    buffer_load_dwordx4 a[116:119], v1, s[20:23], s52 offen offset:1024 sc1
    buffer_load_dwordx4 a[120:123], v1, s[20:23], s52 offen offset:2048 sc1
    buffer_load_dwordx4 a[124:127], v1, s[20:23], s52 offen offset:3072 sc1
    s_waitcnt vmcnt(4)
    s_lshl_b32 s52, s42, 2
    s_add_u32 s52, s52, s41
    s_lshl_b32 s52, s52, 8
    s_lshl_b32 s53, s43, 2
    s_add_u32 s52, s52, s53
    s_add_u32 s52, s52, 10551360
    v_mov_b32 v30, 1073741824
    v_cmp_eq_u32 vcc, 0, v26
    v_mov_b32 v31, s46
    s_nop 0
    v_cndmask_b32 v30, v30, 0, vcc
    buffer_store_dword v31, v30, s[20:23], s52 offen sc1
    s_barrier
    s_add_u32 s52, s86, 28672
    buffer_load_dwordx4 a[0:3], v1, s[20:23], s52 offen offset:0 sc1
    buffer_load_dwordx4 a[4:7], v1, s[20:23], s52 offen offset:1024 sc1
    buffer_load_dwordx4 a[8:11], v1, s[20:23], s52 offen offset:2048 sc1
    buffer_load_dwordx4 a[12:15], v1, s[20:23], s52 offen offset:3072 sc1
    s_mov_b32 s16, s26
    s_mov_b32 s17, s27
    s_mov_b32 s18, 4194304
    s_mov_b32 s19, 0x00020000
    s_mov_b32 s28, s96
    s_mov_b32 s29, s97
    s_mov_b32 s30, 1024
    s_mov_b32 s31, 0x00020000
    v_lshrrev_b32 v31, 5, v26
    v_and_b32 v27, 15, v26
    v_bfe_u32 v28, v26, 4, 1
    v_lshlrev_b32 v27, 2, v27
    v_lshl_add_u32 v27, v28, 8, v27
    v_lshl_add_u32 v18, v31, 6, v27
    s_lshl_b32 s54, s84, 9
    s_add_u32 s54, s54, 10551296
    v_mov_b32 v28, 157216
    s_cmp_lg_u32 s41, 0
    s_cbranch_scc1 F_FWZ
    s_setprio 3
F_FPZ:
    buffer_load_dword v27, v18, s[20:23], s54 offen sc1
    s_waitcnt vmcnt(0)
    v_cmp_ne_u32 vcc, s46, v27
    s_nop 1
    s_cmp_eq_u64 vcc, 0
    s_cbranch_scc1 F_FPZ_OK
    s_sleep 2
    s_branch F_FPZ
F_FPZ_OK:
    v_mov_b32 v27, 1
    ds_write_b32 v28, v27
    s_branch F_FDZ
F_FWZ:
    ds_read_b32 v27, v28
    s_waitcnt lgkmcnt(0)
    v_readfirstlane_b32 s52, v27
    s_cmp_eq_u32 s52, 1
    s_cbranch_scc1 F_FDZ
    s_sleep 1
    s_branch F_FWZ
F_FDZ:
    s_setprio 0
    s_waitcnt lgkmcnt(0)
    s_add_u32 s61, s87, 88064
    buffer_load_dwordx4 v[32:35], v1, s[20:23], s87 offen offset:0 sc1
    buffer_load_dwordx4 v[36:39], v1, s[20:23], s61 offen offset:0 sc1
    buffer_load_dwordx4 v[40:43], v1, s[20:23], s87 offen offset:1024 sc1
    buffer_load_dwordx4 v[44:47], v1, s[20:23], s61 offen offset:1024 sc1
    buffer_load_dwordx4 v[48:51], v1, s[20:23], s87 offen offset:2048 sc1
    buffer_load_dwordx4 v[52:55], v1, s[20:23], s61 offen offset:2048 sc1
    buffer_load_dwordx4 v[56:59], v1, s[20:23], s87 offen offset:3072 sc1
    buffer_load_dwordx4 v[60:63], v1, s[20:23], s61 offen offset:3072 sc1
    s_add_u32 s60, s87, 4096
    buffer_load_dwordx4 v[8:11], v1, s[20:23], s60 offen offset:0 sc1
    s_add_u32 s60, s61, 4096
    buffer_load_dwordx4 v[12:15], v1, s[20:23], s60 offen offset:0 sc1
    s_add_u32 s60, s87, 4096
    buffer_load_dwordx4 v[16:19], v1, s[20:23], s60 offen offset:1024 sc1
    s_add_u32 s60, s61, 4096
    buffer_load_dwordx4 v[20:23], v1, s[20:23], s60 offen offset:1024 sc1
    s_waitcnt vmcnt(10)
    v_mfma_f32_32x32x16_bf16 v[64:79], v[32:35], a[16:19], 0
    v_mfma_f32_32x32x16_bf16 v[96:111], v[36:39], a[16:19], 0
    v_mfma_f32_32x32x16_bf16 v[80:95], v[32:35], a[20:23], 0
    v_mfma_f32_32x32x16_bf16 v[112:127], v[36:39], a[20:23], 0
    s_add_u32 s60, s87, 4096
    buffer_load_dwordx4 v[32:35], v1, s[20:23], s60 offen offset:2048 sc1
    s_add_u32 s60, s61, 4096
    buffer_load_dwordx4 v[36:39], v1, s[20:23], s60 offen offset:2048 sc1
    s_waitcnt vmcnt(10)
    v_mfma_f32_32x32x16_bf16 v[64:79], v[40:43], a[24:27], v[64:79]
    v_mfma_f32_32x32x16_bf16 v[96:111], v[44:47], a[24:27], v[96:111]
    v_mfma_f32_32x32x16_bf16 v[80:95], v[40:43], a[28:31], v[80:95]
    v_mfma_f32_32x32x16_bf16 v[112:127], v[44:47], a[28:31], v[112:127]
    s_add_u32 s60, s87, 4096
    buffer_load_dwordx4 v[40:43], v1, s[20:23], s60 offen offset:3072 sc1
    s_add_u32 s60, s61, 4096
    buffer_load_dwordx4 v[44:47], v1, s[20:23], s60 offen offset:3072 sc1
    s_waitcnt vmcnt(10)
    v_mfma_f32_32x32x16_bf16 v[64:79], v[48:51], a[32:35], v[64:79]
    v_mfma_f32_32x32x16_bf16 v[96:111], v[52:55], a[32:35], v[96:111]
    v_mfma_f32_32x32x16_bf16 v[80:95], v[48:51], a[36:39], v[80:95]
    v_mfma_f32_32x32x16_bf16 v[112:127], v[52:55], a[36:39], v[112:127]
    s_add_u32 s60, s87, 8192
    buffer_load_dwordx4 v[48:51], v1, s[20:23], s60 offen offset:0 sc1
    s_add_u32 s60, s61, 8192
    buffer_load_dwordx4 v[52:55], v1, s[20:23], s60 offen offset:0 sc1
    s_waitcnt vmcnt(10)
    v_mfma_f32_32x32x16_bf16 v[64:79], v[56:59], a[40:43], v[64:79]
    v_mfma_f32_32x32x16_bf16 v[96:111], v[60:63], a[40:43], v[96:111]
    v_mfma_f32_32x32x16_bf16 v[80:95], v[56:59], a[44:47], v[80:95]
    v_mfma_f32_32x32x16_bf16 v[112:127], v[60:63], a[44:47], v[112:127]
    s_add_u32 s60, s87, 8192
    buffer_load_dwordx4 v[56:59], v1, s[20:23], s60 offen offset:1024 sc1
    s_add_u32 s60, s61, 8192
    buffer_load_dwordx4 v[60:63], v1, s[20:23], s60 offen offset:1024 sc1
    s_add_u32 s52, s86, 32768
    buffer_load_dwordx4 a[16:19], v1, s[20:23], s52 offen offset:0 sc1
    buffer_load_dwordx4 a[20:23], v1, s[20:23], s52 offen offset:1024 sc1
    buffer_load_dwordx4 a[24:27], v1, s[20:23], s52 offen offset:2048 sc1
    buffer_load_dwordx4 a[28:31], v1, s[20:23], s52 offen offset:3072 sc1
    s_waitcnt vmcnt(14)
    v_mfma_f32_32x32x16_bf16 v[64:79], v[8:11], a[48:51], v[64:79]
    v_mfma_f32_32x32x16_bf16 v[96:111], v[12:15], a[48:51], v[96:111]
    v_mfma_f32_32x32x16_bf16 v[80:95], v[8:11], a[52:55], v[80:95]
    v_mfma_f32_32x32x16_bf16 v[112:127], v[12:15], a[52:55], v[112:127]
    s_add_u32 s60, s87, 8192
    buffer_load_dwordx4 v[8:11], v1, s[20:23], s60 offen offset:2048 sc1
    s_add_u32 s60, s61, 8192
    buffer_load_dwordx4 v[12:15], v1, s[20:23], s60 offen offset:2048 sc1
    s_waitcnt vmcnt(14)
    v_mfma_f32_32x32x16_bf16 v[64:79], v[16:19], a[56:59], v[64:79]
    v_mfma_f32_32x32x16_bf16 v[96:111], v[20:23], a[56:59], v[96:111]
    v_mfma_f32_32x32x16_bf16 v[80:95], v[16:19], a[60:63], v[80:95]
    v_mfma_f32_32x32x16_bf16 v[112:127], v[20:23], a[60:63], v[112:127]
    s_add_u32 s60, s87, 8192
    buffer_load_dwordx4 v[16:19], v1, s[20:23], s60 offen offset:3072 sc1
    s_add_u32 s60, s61, 8192
    buffer_load_dwordx4 v[20:23], v1, s[20:23], s60 offen offset:3072 sc1
    s_add_u32 s52, s86, 36864
    buffer_load_dwordx4 a[32:35], v1, s[20:23], s52 offen offset:0 sc1
    buffer_load_dwordx4 a[36:39], v1, s[20:23], s52 offen offset:1024 sc1
    buffer_load_dwordx4 a[40:43], v1, s[20:23], s52 offen offset:2048 sc1
    buffer_load_dwordx4 a[44:47], v1, s[20:23], s52 offen offset:3072 sc1
    s_waitcnt vmcnt(18)
    v_mfma_f32_32x32x16_bf16 v[64:79], v[32:35], a[64:67], v[64:79]
    v_mfma_f32_32x32x16_bf16 v[96:111], v[36:39], a[64:67], v[96:111]
    v_mfma_f32_32x32x16_bf16 v[80:95], v[32:35], a[68:71], v[80:95]
    v_mfma_f32_32x32x16_bf16 v[112:127], v[36:39], a[68:71], v[112:127]
    s_add_u32 s60, s87, 12288
    buffer_load_dwordx4 v[32:35], v1, s[20:23], s60 offen offset:0 sc1
    s_add_u32 s60, s61, 12288
    buffer_load_dwordx4 v[36:39], v1, s[20:23], s60 offen offset:0 sc1
    s_waitcnt vmcnt(18)
    v_mfma_f32_32x32x16_bf16 v[64:79], v[40:43], a[72:75], v[64:79]
    v_mfma_f32_32x32x16_bf16 v[96:111], v[44:47], a[72:75], v[96:111]
    v_mfma_f32_32x32x16_bf16 v[80:95], v[40:43], a[76:79], v[80:95]
    v_mfma_f32_32x32x16_bf16 v[112:127], v[44:47], a[76:79], v[112:127]
    s_add_u32 s60, s87, 12288
    buffer_load_dwordx4 v[40:43], v1, s[20:23], s60 offen offset:1024 sc1
    s_add_u32 s60, s61, 12288
    buffer_load_dwordx4 v[44:47], v1, s[20:23], s60 offen offset:1024 sc1
    s_add_u32 s52, s86, 40960
    s_add_u32 s52, s52, s100
    buffer_load_dwordx4 a[48:51], v1, s[20:23], s52 offen offset:0 sc1
    buffer_load_dwordx4 a[52:55], v1, s[20:23], s52 offen offset:1024 sc1
    buffer_load_dwordx4 a[56:59], v1, s[20:23], s52 offen offset:2048 sc1
    buffer_load_dwordx4 a[60:63], v1, s[20:23], s52 offen offset:3072 sc1
    s_waitcnt vmcnt(22)
    v_mfma_f32_32x32x16_bf16 v[64:79], v[48:51], a[80:83], v[64:79]
    v_mfma_f32_32x32x16_bf16 v[96:111], v[52:55], a[80:83], v[96:111]
    v_mfma_f32_32x32x16_bf16 v[80:95], v[48:51], a[84:87], v[80:95]
    v_mfma_f32_32x32x16_bf16 v[112:127], v[52:55], a[84:87], v[112:127]
    s_add_u32 s60, s87, 12288
    buffer_load_dwordx4 v[48:51], v1, s[20:23], s60 offen offset:2048 sc1
    s_add_u32 s60, s61, 12288
    buffer_load_dwordx4 v[52:55], v1, s[20:23], s60 offen offset:2048 sc1
    s_waitcnt vmcnt(22)
    v_mfma_f32_32x32x16_bf16 v[64:79], v[56:59], a[88:91], v[64:79]
    v_mfma_f32_32x32x16_bf16 v[96:111], v[60:63], a[88:91], v[96:111]
    v_mfma_f32_32x32x16_bf16 v[80:95], v[56:59], a[92:95], v[80:95]
    v_mfma_f32_32x32x16_bf16 v[112:127], v[60:63], a[92:95], v[112:127]
    s_add_u32 s60, s87, 12288
    buffer_load_dwordx4 v[56:59], v1, s[20:23], s60 offen offset:3072 sc1
    s_add_u32 s60, s61, 12288
    buffer_load_dwordx4 v[60:63], v1, s[20:23], s60 offen offset:3072 sc1
    s_waitcnt vmcnt(18)
    v_mfma_f32_32x32x16_bf16 v[64:79], v[8:11], a[96:99], v[64:79]
    v_mfma_f32_32x32x16_bf16 v[96:111], v[12:15], a[96:99], v[96:111]
    v_mfma_f32_32x32x16_bf16 v[80:95], v[8:11], a[100:103], v[80:95]
    v_mfma_f32_32x32x16_bf16 v[112:127], v[12:15], a[100:103], v[112:127]
    s_add_u32 s60, s87, 16384
    buffer_load_dwordx4 v[8:11], v1, s[20:23], s60 offen offset:0 sc1
    s_add_u32 s60, s61, 16384
    buffer_load_dwordx4 v[12:15], v1, s[20:23], s60 offen offset:0 sc1
    s_waitcnt vmcnt(18)
    v_mfma_f32_32x32x16_bf16 v[64:79], v[16:19], a[104:107], v[64:79]
    v_mfma_f32_32x32x16_bf16 v[96:111], v[20:23], a[104:107], v[96:111]
    v_mfma_f32_32x32x16_bf16 v[80:95], v[16:19], a[108:111], v[80:95]
    v_mfma_f32_32x32x16_bf16 v[112:127], v[20:23], a[108:111], v[112:127]
    s_add_u32 s60, s87, 16384
    buffer_load_dwordx4 v[16:19], v1, s[20:23], s60 offen offset:1024 sc1
    s_add_u32 s60, s61, 16384
    buffer_load_dwordx4 v[20:23], v1, s[20:23], s60 offen offset:1024 sc1
    s_waitcnt vmcnt(14)
    v_mfma_f32_32x32x16_bf16 v[64:79], v[32:35], a[112:115], v[64:79]
    v_mfma_f32_32x32x16_bf16 v[96:111], v[36:39], a[112:115], v[96:111]
    v_mfma_f32_32x32x16_bf16 v[80:95], v[32:35], a[116:119], v[80:95]
    v_mfma_f32_32x32x16_bf16 v[112:127], v[36:39], a[116:119], v[112:127]
    s_add_u32 s60, s87, 16384
    buffer_load_dwordx4 v[32:35], v1, s[20:23], s60 offen offset:2048 sc1
    s_add_u32 s60, s61, 16384
    buffer_load_dwordx4 v[36:39], v1, s[20:23], s60 offen offset:2048 sc1
    s_waitcnt vmcnt(14)
    v_mfma_f32_32x32x16_bf16 v[64:79], v[40:43], a[120:123], v[64:79]
    v_mfma_f32_32x32x16_bf16 v[96:111], v[44:47], a[120:123], v[96:111]
    v_mfma_f32_32x32x16_bf16 v[80:95], v[40:43], a[124:127], v[80:95]
    v_mfma_f32_32x32x16_bf16 v[112:127], v[44:47], a[124:127], v[112:127]
    s_add_u32 s60, s87, 16384
    buffer_load_dwordx4 v[40:43], v1, s[20:23], s60 offen offset:3072 sc1
    s_add_u32 s60, s61, 16384
    buffer_load_dwordx4 v[44:47], v1, s[20:23], s60 offen offset:3072 sc1
    s_waitcnt vmcnt(10)
    v_mfma_f32_32x32x16_bf16 v[64:79], v[48:51], a[0:3], v[64:79]
    v_mfma_f32_32x32x16_bf16 v[96:111], v[52:55], a[0:3], v[96:111]
    v_mfma_f32_32x32x16_bf16 v[80:95], v[48:51], a[4:7], v[80:95]
    v_mfma_f32_32x32x16_bf16 v[112:127], v[52:55], a[4:7], v[112:127]
    s_add_u32 s60, s87, 20480
    s_add_u32 s60, s60, s100
    buffer_load_dwordx4 v[48:51], v1, s[20:23], s60 offen offset:0 sc1
    s_add_u32 s60, s61, 20480
    s_add_u32 s60, s60, s100
    buffer_load_dwordx4 v[52:55], v1, s[20:23], s60 offen offset:0 sc1
    s_waitcnt vmcnt(10)
    v_mfma_f32_32x32x16_bf16 v[64:79], v[56:59], a[8:11], v[64:79]
    v_mfma_f32_32x32x16_bf16 v[96:111], v[60:63], a[8:11], v[96:111]
    v_mfma_f32_32x32x16_bf16 v[80:95], v[56:59], a[12:15], v[80:95]
    v_mfma_f32_32x32x16_bf16 v[112:127], v[60:63], a[12:15], v[112:127]
    s_add_u32 s60, s87, 20480
    s_add_u32 s60, s60, s100
    buffer_load_dwordx4 v[56:59], v1, s[20:23], s60 offen offset:1024 sc1
    s_add_u32 s60, s61, 20480
    s_add_u32 s60, s60, s100
    buffer_load_dwordx4 v[60:63], v1, s[20:23], s60 offen offset:1024 sc1
    s_waitcnt vmcnt(10)
    v_mfma_f32_32x32x16_bf16 v[64:79], v[8:11], a[16:19], v[64:79]
    v_mfma_f32_32x32x16_bf16 v[96:111], v[12:15], a[16:19], v[96:111]
    v_mfma_f32_32x32x16_bf16 v[80:95], v[8:11], a[20:23], v[80:95]
    v_mfma_f32_32x32x16_bf16 v[112:127], v[12:15], a[20:23], v[112:127]
    s_waitcnt vmcnt(8)
    v_mfma_f32_32x32x16_bf16 v[64:79], v[16:19], a[24:27], v[64:79]
    v_mfma_f32_32x32x16_bf16 v[96:111], v[20:23], a[24:27], v[96:111]
    v_mfma_f32_32x32x16_bf16 v[80:95], v[16:19], a[28:31], v[80:95]
    v_mfma_f32_32x32x16_bf16 v[112:127], v[20:23], a[28:31], v[112:127]
    v_and_b32 v27, 31, v26
    v_lshrrev_b32 v31, 5, v26
    s_lshl_b32 s52, s84, 6
    s_lshr_b32 s53, s40, 2
    s_lshl_b32 s53, s53, 5
    s_add_u32 s52, s52, s53
    s_and_b32 s53, s40, 1
    s_lshl_b32 s53, s53, 3
    s_add_u32 s52, s52, s53
    s_lshl_b32 s53, s85, 6
    s_bfe_u32 s54, s40, 0x10001
    s_lshl_b32 s54, s54, 5
    s_add_u32 s53, s53, s54
    v_lshl_add_u32 v28, v31, 4, s52
    v_add_u32 v29, s53, v27
    v_lshl_add_u32 v30, v28, 9, v29
    v_lshlrev_b32 v17, 2, v30
    v_lshlrev_b32 v30, 1, v30
    buffer_load_ushort v8, v30, s[8:11], 0 offen offset:0
    buffer_load_ushort v9, v30, s[8:11], 0 offen offset:1024
    buffer_load_ushort v10, v30, s[8:11], 0 offen offset:2048
    buffer_load_ushort v11, v30, s[8:11], 0 offen offset:3072
    s_movk_i32 s54, 0x1000
    buffer_load_ushort v12, v30, s[8:11], s54 offen offset:0
    buffer_load_ushort v13, v30, s[8:11], s54 offen offset:1024
    buffer_load_ushort v14, v30, s[8:11], s54 offen offset:2048
    buffer_load_ushort v15, v30, s[8:11], s54 offen offset:3072
    v_lshlrev_b32 v29, 1, v29
    buffer_load_ushort v16, v29, s[28:31], 0 offen
    v_lshlrev_b32 v19, 3, v28
    s_waitcnt vmcnt(15)
    v_mfma_f32_32x32x16_bf16 v[64:79], v[32:35], a[32:35], v[64:79]
    v_mfma_f32_32x32x16_bf16 v[96:111], v[36:39], a[32:35], v[96:111]
    v_mfma_f32_32x32x16_bf16 v[80:95], v[32:35], a[36:39], v[80:95]
    v_mfma_f32_32x32x16_bf16 v[112:127], v[36:39], a[36:39], v[112:127]
    s_waitcnt vmcnt(13)
    v_mfma_f32_32x32x16_bf16 v[64:79], v[40:43], a[40:43], v[64:79]
    v_mfma_f32_32x32x16_bf16 v[96:111], v[44:47], a[40:43], v[96:111]
    v_mfma_f32_32x32x16_bf16 v[80:95], v[40:43], a[44:47], v[80:95]
    v_mfma_f32_32x32x16_bf16 v[112:127], v[44:47], a[44:47], v[112:127]
    s_mov_b32 s55, 10485760
    buffer_load_dwordx4 v[32:35], v19, s[20:23], s55 offen offset:0 sc1
    buffer_load_dwordx4 v[36:39], v19, s[20:23], s55 offen offset:16 sc1
    buffer_load_dwordx4 v[40:43], v19, s[20:23], s55 offen offset:32 sc1
    buffer_load_dwordx4 v[44:47], v19, s[20:23], s55 offen offset:48 sc1
    s_waitcnt vmcnt(15)
    v_mfma_f32_32x32x16_bf16 v[64:79], v[48:51], a[48:51], v[64:79]
    v_mfma_f32_32x32x16_bf16 v[96:111], v[52:55], a[48:51], v[96:111]
    v_mfma_f32_32x32x16_bf16 v[80:95], v[48:51], a[52:55], v[80:95]
    v_mfma_f32_32x32x16_bf16 v[112:127], v[52:55], a[52:55], v[112:127]
    s_waitcnt vmcnt(13)
    v_mfma_f32_32x32x16_bf16 v[64:79], v[56:59], a[56:59], v[64:79]
    v_mfma_f32_32x32x16_bf16 v[96:111], v[60:63], a[56:59], v[96:111]
    v_mfma_f32_32x32x16_bf16 v[80:95], v[56:59], a[60:63], v[80:95]
    v_mfma_f32_32x32x16_bf16 v[112:127], v[60:63], a[60:63], v[112:127]
F_RED:
RESET_red:
    s_lshl_b32 s99, s40, 14
    v_add_u32 v2, s99, v1
    s_lshl_b32 s53, s40, 11
    v_add_u32 v3, s53, v1
    v_add_u32 v4, 0x10000, v3
    s_waitcnt lgkmcnt(0)
    s_nop 2
    ds_write_b128 v2, v[64:67] offset:0
    s_nop 1
    ds_write_b128 v2, v[68:71] offset:1024
    s_nop 0
    ds_write_b128 v2, v[72:75] offset:2048
    ds_write_b128 v2, v[76:79] offset:3072
    s_nop 0
    ds_write_b128 v2, v[80:83] offset:4096
    ds_write_b128 v2, v[84:87] offset:5120
    ds_write_b128 v2, v[88:91] offset:6144
    ds_write_b128 v2, v[92:95] offset:7168
    ds_write_b128 v2, v[96:99] offset:8192
    ds_write_b128 v2, v[100:103] offset:9216
    ds_write_b128 v2, v[104:107] offset:10240
    ds_write_b128 v2, v[108:111] offset:11264
    ds_write_b128 v2, v[112:115] offset:12288
    ds_write_b128 v2, v[116:119] offset:13312
    ds_write_b128 v2, v[120:123] offset:14336
    ds_write_b128 v2, v[124:127] offset:15360
    s_waitcnt vmcnt(0)
    v_lshlrev_b32 v16, 16, v16
    v_lshlrev_b32 v8, 16, v8
    v_lshlrev_b32 v9, 16, v9
    v_lshlrev_b32 v10, 16, v10
    v_lshlrev_b32 v11, 16, v11
    v_lshlrev_b32 v12, 16, v12
    v_lshlrev_b32 v13, 16, v13
    v_lshlrev_b32 v14, 16, v14
    v_lshlrev_b32 v15, 16, v15
    v_sub_f32 v48, v8, v32
    v_sub_f32 v49, v9, v34
    v_sub_f32 v50, v10, v36
    v_sub_f32 v51, v11, v38
    v_sub_f32 v52, v12, v40
    v_sub_f32 v53, v13, v42
    v_sub_f32 v54, v14, v44
    v_sub_f32 v55, v15, v46
    v_cvt_pk_bf16_f32 v20, v48, v49
    v_cvt_pk_bf16_f32 v21, v50, v51
    v_cvt_pk_bf16_f32 v22, v52, v53
    v_cvt_pk_bf16_f32 v23, v54, v55
    v_lshlrev_b32 v48, 16, v20
    v_and_b32 v49, s59, v20
    v_lshlrev_b32 v50, 16, v21
    v_and_b32 v51, s59, v21
    v_lshlrev_b32 v52, 16, v22
    v_and_b32 v53, s59, v22
    v_lshlrev_b32 v54, 16, v23
    v_and_b32 v55, s59, v23
    v_mul_f32 v48, v48, v33
    v_mul_f32 v49, v49, v35
    v_mul_f32 v50, v50, v37
    v_mul_f32 v51, v51, v39
    v_mul_f32 v52, v52, v41
    v_mul_f32 v53, v53, v43
    v_mul_f32 v54, v54, v45
    v_mul_f32 v55, v55, v47
    v_cvt_pk_bf16_f32 v20, v48, v49
    v_cvt_pk_bf16_f32 v21, v50, v51
    v_cvt_pk_bf16_f32 v22, v52, v53
    v_cvt_pk_bf16_f32 v23, v54, v55
    v_lshlrev_b32 v48, 16, v20
    v_and_b32 v49, s59, v20
    v_lshlrev_b32 v50, 16, v21
    v_and_b32 v51, s59, v21
    v_lshlrev_b32 v52, 16, v22
    v_and_b32 v53, s59, v22
    v_lshlrev_b32 v54, 16, v23
    v_and_b32 v55, s59, v23
    v_mul_f32 v48, v48, v16
    v_mul_f32 v49, v49, v16
    v_mul_f32 v50, v50, v16
    v_mul_f32 v51, v51, v16
    v_mul_f32 v52, v52, v16
    v_mul_f32 v53, v53, v16
    v_mul_f32 v54, v54, v16
    v_mul_f32 v55, v55, v16
    v_cvt_pk_bf16_f32 v20, v48, v49
    v_cvt_pk_bf16_f32 v21, v50, v51
    v_cvt_pk_bf16_f32 v22, v52, v53
    v_cvt_pk_bf16_f32 v23, v54, v55
    v_lshlrev_b32 v48, 16, v20
    v_and_b32 v49, s59, v20
    v_lshlrev_b32 v50, 16, v21
    v_and_b32 v51, s59, v21
    v_lshlrev_b32 v52, 16, v22
    v_and_b32 v53, s59, v22
    v_lshlrev_b32 v54, 16, v23
    v_and_b32 v55, s59, v23
    s_waitcnt lgkmcnt(0)
    s_barrier
    ds_read_b128 v[64:67], v4 offset:0
    ds_read_b128 v[68:71], v4 offset:1024
    ds_read_b128 v[72:75], v4 offset:16384
    ds_read_b128 v[76:79], v4 offset:17408
    ds_read_b128 v[80:83], v4 offset:32768
    ds_read_b128 v[84:87], v4 offset:33792
    ds_read_b128 v[88:91], v4 offset:49152
    ds_read_b128 v[92:95], v4 offset:50176
    ds_read_b128 v[96:99], v3 offset:0
    ds_read_b128 v[100:103], v3 offset:1024
    ds_read_b128 v[104:107], v3 offset:16384
    ds_read_b128 v[108:111], v3 offset:17408
    ds_read_b128 v[112:115], v3 offset:32768
    ds_read_b128 v[116:119], v3 offset:33792
    ds_read_b128 v[120:123], v3 offset:49152
    ds_read_b128 v[124:127], v3 offset:50176
    v_mov_b32 v5, 1073741824
    v_cmp_eq_u32 vcc, 0, v0
    s_lshl_b32 s52, s85, 5
    s_add_u32 s52, s52, s84
    s_cmp_eq_u32 s52, 31
    s_cselect_b32 s52, 12582912, 1073741824
    v_cndmask_b32 v5, v5, 0, vcc
    v_mov_b32 v6, s46
    buffer_store_dword v6, v5, s[20:23], s52 offen
    s_waitcnt lgkmcnt(8)
    v_add_f32 v56, v64, v72
    v_add_f32 v57, v65, v73
    v_add_f32 v58, v66, v74
    v_add_f32 v59, v67, v75
    v_add_f32 v60, v68, v76
    v_add_f32 v61, v69, v77
    v_add_f32 v62, v70, v78
    v_add_f32 v63, v71, v79
    v_add_f32 v32, v80, v88
    v_add_f32 v33, v81, v89
    v_add_f32 v34, v82, v90
    v_add_f32 v35, v83, v91
    v_add_f32 v36, v84, v92
    v_add_f32 v37, v85, v93
    v_add_f32 v38, v86, v94
    v_add_f32 v39, v87, v95
    v_add_f32 v56, v56, v32
    v_add_f32 v57, v57, v33
    v_add_f32 v58, v58, v34
    v_add_f32 v59, v59, v35
    v_add_f32 v60, v60, v36
    v_add_f32 v61, v61, v37
    v_add_f32 v62, v62, v38
    v_add_f32 v63, v63, v39
    v_cvt_pk_bf16_f32 v20, v56, v57
    v_cvt_pk_bf16_f32 v21, v58, v59
    v_cvt_pk_bf16_f32 v22, v60, v61
    v_cvt_pk_bf16_f32 v23, v62, v63
    v_lshlrev_b32 v56, 16, v20
    v_and_b32 v57, s59, v20
    v_lshlrev_b32 v58, 16, v21
    v_and_b32 v59, s59, v21
    v_lshlrev_b32 v60, 16, v22
    v_and_b32 v61, s59, v22
    v_lshlrev_b32 v62, 16, v23
    v_and_b32 v63, s59, v23
    s_mov_b32 s53, 0xbfb8aa3b
    v_mul_f32 v32, s53, v56
    v_mul_f32 v33, s53, v57
    v_mul_f32 v34, s53, v58
    v_mul_f32 v35, s53, v59
    v_mul_f32 v36, s53, v60
    v_mul_f32 v37, s53, v61
    v_mul_f32 v38, s53, v62
    v_mul_f32 v39, s53, v63
    v_exp_f32 v32, v32
    v_exp_f32 v33, v33
    v_exp_f32 v34, v34
    v_exp_f32 v35, v35
    v_exp_f32 v36, v36
    v_exp_f32 v37, v37
    v_exp_f32 v38, v38
    v_exp_f32 v39, v39
    s_waitcnt lgkmcnt(0)
    v_add_f32 v96, v96, v104
    v_add_f32 v97, v97, v105
    v_add_f32 v98, v98, v106
    v_add_f32 v99, v99, v107
    v_add_f32 v100, v100, v108
    v_add_f32 v101, v101, v109
    v_add_f32 v102, v102, v110
    v_add_f32 v103, v103, v111
    v_add_f32 v32, 1.0, v32
    v_add_f32 v33, 1.0, v33
    v_add_f32 v34, 1.0, v34
    v_add_f32 v35, 1.0, v35
    v_add_f32 v36, 1.0, v36
    v_add_f32 v37, 1.0, v37
    v_add_f32 v38, 1.0, v38
    v_add_f32 v39, 1.0, v39
    v_rcp_f32 v32, v32
    v_rcp_f32 v33, v33
    v_rcp_f32 v34, v34
    v_rcp_f32 v35, v35
    v_rcp_f32 v36, v36
    v_rcp_f32 v37, v37
    v_rcp_f32 v38, v38
    v_rcp_f32 v39, v39
    v_add_f32 v112, v112, v120
    v_add_f32 v113, v113, v121
    v_add_f32 v114, v114, v122
    v_add_f32 v115, v115, v123
    v_add_f32 v116, v116, v124
    v_add_f32 v117, v117, v125
    v_add_f32 v118, v118, v126
    v_add_f32 v119, v119, v127
    v_add_f32 v96, v96, v112
    v_add_f32 v97, v97, v113
    v_add_f32 v98, v98, v114
    v_add_f32 v99, v99, v115
    v_add_f32 v100, v100, v116
    v_add_f32 v101, v101, v117
    v_add_f32 v102, v102, v118
    v_add_f32 v103, v103, v119
    v_mul_f32 v32, v32, v56
    v_mul_f32 v33, v33, v57
    v_mul_f32 v34, v34, v58
    v_mul_f32 v35, v35, v59
    v_mul_f32 v36, v36, v60
    v_mul_f32 v37, v37, v61
    v_mul_f32 v38, v38, v62
    v_mul_f32 v39, v39, v63
    v_add_f32 v48, v48, v96
    v_add_f32 v49, v49, v97
    v_add_f32 v50, v50, v98
    v_add_f32 v51, v51, v99
    v_add_f32 v52, v52, v100
    v_add_f32 v53, v53, v101
    v_add_f32 v54, v54, v102
    v_add_f32 v55, v55, v103
    v_cvt_pk_bf16_f32 v20, v32, v33
    v_cvt_pk_bf16_f32 v21, v34, v35
    v_cvt_pk_bf16_f32 v22, v36, v37
    v_cvt_pk_bf16_f32 v23, v38, v39
    v_lshlrev_b32 v32, 16, v20
    v_and_b32 v33, s59, v20
    v_lshlrev_b32 v34, 16, v21
    v_and_b32 v35, s59, v21
    v_lshlrev_b32 v36, 16, v22
    v_and_b32 v37, s59, v22
    v_lshlrev_b32 v38, 16, v23
    v_and_b32 v39, s59, v23
    v_fma_f32 v8, v48, v32, v8
    v_fma_f32 v9, v49, v33, v9
    v_fma_f32 v10, v50, v34, v10
    v_fma_f32 v11, v51, v35, v11
    v_fma_f32 v12, v52, v36, v12
    v_fma_f32 v13, v53, v37, v13
    v_fma_f32 v14, v54, v38, v14
    v_fma_f32 v15, v55, v39, v15
    buffer_store_dword v8, v17, s[16:19], 0 offen offset:0
    buffer_store_dword v9, v17, s[16:19], 0 offen offset:2048
    v_add_u32 v17, 0x1000, v17
    buffer_store_dword v10, v17, s[16:19], 0 offen offset:0
    buffer_store_dword v11, v17, s[16:19], 0 offen offset:2048
    v_add_u32 v17, 0x1000, v17
    buffer_store_dword v12, v17, s[16:19], 0 offen offset:0
    buffer_store_dword v13, v17, s[16:19], 0 offen offset:2048
    v_add_u32 v17, 0x1000, v17
    buffer_store_dword v14, v17, s[16:19], 0 offen offset:0
    buffer_store_dword v15, v17, s[16:19], 0 offen offset:2048
F_END:
    s_endpgm
.section .rodata,"a"
.p2align 6
.amdhsa_kernel recurrent_scan__ssm_conv_s5__glu_gated_reglu__prompt_kernel
  .amdhsa_next_free_vgpr 256
  .amdhsa_next_free_sgpr 102
  .amdhsa_accum_offset 128
  .amdhsa_group_segment_fixed_size 0
  .amdhsa_kernarg_size 128
  .amdhsa_user_sgpr_count 2
  .amdhsa_user_sgpr_kernarg_segment_ptr 1
  .amdhsa_system_sgpr_workgroup_id_x 1
  .amdhsa_float_denorm_mode_32 3
.end_amdhsa_kernel
```
